```python
import torch

def _softmax(x, axis=-1):
    return torch.softmax(x, dim=axis)
def _gelu(x):
    return torch.nn.functional.gelu(x, approximate="tanh")
def _silu(x):
    return torch.nn.functional.silu(x)
def _sigmoid(x):
    return torch.sigmoid(x)
def _layernorm(x, axis=-1, eps=1e-5):
    m = x.mean(dim=axis, keepdim=True)
    v = x.var(dim=axis, keepdim=True, unbiased=False)
    return (x - m) / torch.sqrt(v + eps)
def _scatter_add(tgt, idx, src, axis=0):
    return tgt.clone().index_add_(axis, idx, src)
def _segment_sum(src, seg, n):
    out = torch.zeros((n,) + src.shape[1:], dtype=src.dtype)
    return out.index_add_(0, seg, src)
def _pad(x, pw):
    flat = tuple(v for pair in reversed(pw) for v in pair)
    return torch.nn.functional.pad(x, flat)

kernel_name = 'concat_heads__mha_block__mha_block__prompt'

def setup_inputs():

    _w = (lambda a: (lambda t: t.to(torch.bfloat16) if t.is_floating_point() else t)(torch.as_tensor(a)))
    def _A_setup():
        B, S, D, H = 1, 2048, 512, 32
        return {
            "x": _w((lambda *s: torch.randn(*s, dtype=torch.bfloat16) * 0.2)(B, S, D)),
            "wqkv": _w((lambda *s: torch.randn(*s, dtype=torch.bfloat16) * 0.2)(D, 3 * D)),
            "wo": _w((lambda *s: torch.randn(*s, dtype=torch.bfloat16) * 0.05)(D, D)),
        }
    _A_in = _A_setup()

    def _B_setup():
        B, S, D, H = 1, 2048, 512, 32
        return {
            "x": _w((lambda *s: torch.randn(*s, dtype=torch.bfloat16) * 0.2)(B, S, D)),
            "wqkv": _w((lambda *s: torch.randn(*s, dtype=torch.bfloat16) * 0.2)(D, 3 * D)),
            "wo": _w((lambda *s: torch.randn(*s, dtype=torch.bfloat16) * 0.05)(D, D)),
        }
    _B_in = _B_setup()

    return {
        "A_x": _A_in["x"],
        "A_wqkv": _A_in["wqkv"],
        "A_wo": _A_in["wo"],
        "B_x": _B_in["x"],
        "B_wqkv": _B_in["wqkv"],
        "B_wo": _B_in["wo"],
    }

def reference(A_x, A_wqkv, A_wo, B_x, B_wqkv, B_wo):
    def _A_ref(x, wqkv, wo):
        B, S, D = x.shape
        H = 32
        Dh = D // H
        qkv = (lambda x, *d: x.permute(*d))((x @ wqkv).reshape(B, S, 3, H, Dh), 2, 0, 3, 1, 4)
        q, k, v = qkv[0], qkv[1], qkv[2]
        scores = torch.einsum("bhqd,bhkd->bhqk", q, k) * (Dh ** -0.5)
        p = _softmax(scores, axis=-1)
        o = torch.einsum("bhqk,bhkd->bhqd", p, v)
        return (lambda x, *d: x.permute(*d))(o, 0, 2, 1, 3).reshape(B, S, D) @ wo

    def _B_ref(x, wqkv, wo):
        B, S, D = x.shape
        H = 32
        Dh = D // H
        qkv = (lambda x, *d: x.permute(*d))((x @ wqkv).reshape(B, S, 3, H, Dh), 2, 0, 3, 1, 4)
        q, k, v = qkv[0], qkv[1], qkv[2]
        scores = torch.einsum("bhqd,bhkd->bhqk", q, k) * (Dh ** -0.5)
        p = _softmax(scores, axis=-1)
        o = torch.einsum("bhqk,bhkd->bhqd", p, v)
        return (lambda x, *d: x.permute(*d))(o, 0, 2, 1, 3).reshape(B, S, D) @ wo

    a = _A_ref(A_x, A_wqkv, A_wo)
    b = _B_ref(B_x, B_wqkv, B_wo)
    return torch.concatenate([a, b], axis=-1)
```

```asm
; @launch grid=(256,1,1) block=(512,1,1) lds=163840
.amdgcn_target "amdgcn-amd-amdhsa--gfx950"
.text
.globl concat_heads__mha_block__mha_block__prompt_kernel
.p2align 8
.type concat_heads__mha_block__mha_block__prompt_kernel,@function
concat_heads__mha_block__mha_block__prompt_kernel:
    s_cmp_ge_u32 s2, 256
    s_cbranch_scc1 L_end
    s_load_dwordx8 s[20:27], s[0:1], 0
    s_load_dwordx4 s[28:31], s[0:1], 32
    s_load_dwordx4 s[32:35], s[0:1], 56
    s_load_dwordx2 s[36:37], s[0:1], 48
    v_lshrrev_b32 v3, 6, v0
    v_and_b32 v1, 63, v0
    v_lshlrev_b32 v2, 4, v1
    v_readfirstlane_b32 s3, v3
    s_and_b32 s4, s2, 7
    s_lshr_b32 s5, s2, 3
    s_lshr_b32 s6, s4, 2
    s_and_b32 s44, s4, 1
    s_lshl_b32 s44, s44, 3
    s_lshr_b32 s38, s5, 2
    s_add_u32 s44, s44, s38
    s_and_b32 s45, s4, 2
    s_lshl_b32 s45, s45, 1
    s_and_b32 s38, s5, 3
    s_add_u32 s45, s45, s38
    s_mov_b32 s10, 12713984
    s_mov_b32 s11, 0x20000
    s_and_b32 s39, s3, 3
    v_lshrrev_b32 v16, 3, v1
    v_lshrrev_b32 v17, 4, v1
    v_and_b32 v18, 7, v1
    v_xor_b32 v19, v18, v17
    v_lshlrev_b32 v19, 4, v19
    v_lshl_add_u32 v4, v16, 10, v19
    v_xor_b32 v5, 64, v4
    v_add_u32 v5, 7168, v5
    v_add_u32 v6, 14336, v4
    v_add_u32 v7, 14336, v5
    s_lshl_b32 s48, s45, 18
    s_lshl_b32 s38, s39, 16
    s_add_u32 s48, s48, s38
    s_lshl_b32 s50, s39, 13
    s_lshl_b32 s52, s44, 1
    s_and_b32 s52, s52, 7
    s_mov_b32 s14, 2097152
    s_mov_b32 s15, 0x20000
    s_cmp_ge_u32 s3, 4
    s_cbranch_scc0 L_qkv_compute
    v_lshrrev_b32 v16, 2, v1
    v_mul_u32_u24 v8, 3072, v16
    v_and_b32 v16, 3, v1
    v_lshl_add_u32 v8, v16, 4, v8
    s_mul_i32 s49, s39, 49152
    s_lshl_b32 s38, s44, 6
    s_add_u32 s49, s49, s38
    s_mul_i32 s51, s39, 3072
    s_add_u32 s51, s51, 98304
    s_mov_b32 s18, 1572864
    s_mov_b32 s19, 0x20000
    s_waitcnt lgkmcnt(0)
    s_cmp_eq_u32 s6, 0
    s_cselect_b64 s[12:13], s[20:21], s[26:27]
    s_cselect_b64 s[16:17], s[22:23], s[28:29]
    s_cselect_b64 s[30:31], s[24:25], s[30:31]
    s_mov_b32 s53, 0
    s_mov_b32 s46, 0
L_qkv_ld:
    s_mul_i32 s38, s46, 12288
    s_add_u32 m0, s38, s51
    s_mul_i32 s40, s52, 196608
    s_add_u32 s40, s40, s49
    buffer_load_dwordx4 v8, s[16:19], s40 offen offset:0 lds
    buffer_load_dwordx4 v8, s[16:19], s40 offen offset:1024 lds
    buffer_load_dwordx4 v8, s[16:19], s40 offen offset:2048 lds
    s_lshl_b32 s38, s46, 15
    s_add_u32 m0, s38, s50
    s_lshl_b32 s40, s52, 7
    s_add_u32 s40, s40, s48
    buffer_load_dwordx4 v4, s[12:15], s40 offen offset:0 lds
    buffer_load_dwordx4 v5, s[12:15], s40 offen offset:1024 lds
    buffer_load_dwordx4 v6, s[12:15], s40 offen offset:2048 lds
    buffer_load_dwordx4 v7, s[12:15], s40 offen offset:3072 lds
    s_add_u32 m0, m0, 4096
    s_add_u32 s40, s40, 32768
    buffer_load_dwordx4 v4, s[12:15], s40 offen offset:0 lds
    buffer_load_dwordx4 v5, s[12:15], s40 offen offset:1024 lds
    buffer_load_dwordx4 v6, s[12:15], s40 offen offset:2048 lds
    buffer_load_dwordx4 v7, s[12:15], s40 offen offset:3072 lds
    s_add_u32 s52, s52, 1
    s_and_b32 s52, s52, 7
    s_add_u32 s46, s46, 1
    s_cmp_eq_u32 s46, 3
    s_cselect_b32 s46, 0, s46
    s_add_u32 s53, s53, 1
    s_cmp_eq_u32 s53, 1
    s_cbranch_scc1 L_qkv_ld
    s_waitcnt vmcnt(11)
    s_barrier
    s_cmp_lt_u32 s53, 8
    s_cbranch_scc1 L_qkv_ld
    s_mov_b32 s8, s34
    s_mov_b32 s9, s35
    s_waitcnt vmcnt(0)
    s_barrier
    s_cmp_lg_u32 s3, 4
    s_cbranch_scc1 L_tag_skip
    s_mov_b32 s12, s32
    s_mov_b32 s13, s33
    s_mov_b32 s14, 256
    s_mov_b32 s15, 0x20000
    v_mov_b32 v8, 0
    s_mov_b32 s38, 0x40000
L_tag:
    buffer_load_dword v9, v8, s[12:15], 0 offen sc1
    s_waitcnt vmcnt(0)
    v_cmp_eq_u32 vcc, 0, v9
    s_sub_u32 s38, s38, 1
    s_cbranch_scc1 L_tag_x
    s_cbranch_vccnz L_tag
L_tag_x:
    v_mov_b32 v8, 147456
    ds_write_b32 v8, v9
L_tag_skip:
    v_mov_b32 v8, 0x3f803f80
    v_and_b32 v12, 1, v1
    v_cmp_eq_u32 vcc, 0, v12
    s_lshl_b32 s38, s3, 11
    v_add_u32 v12, s38, v2
    v_add_u32 v12, 131072, v12
    v_cndmask_b32 v8, 0, v8, vcc
    v_mov_b32 v9, v8
    v_mov_b32 v10, v8
    v_mov_b32 v11, v8
    ds_write_b128 v12, v[8:11]
    ds_write_b128 v12, v[8:11] offset:1024
    s_and_b32 s46, s4, 3
    s_lshl_b32 s46, s46, 2
    s_lshr_b32 s38, s5, 3
    s_add_u32 s46, s46, s38
    s_and_b32 s47, s5, 7
    s_lshl_b32 s38, s6, 4
    s_add_u32 s38, s38, s44
    s_lshl_b32 s54, s38, 17
    s_lshl_b32 s57, s3, 10
    s_add_u32 s54, s54, s57
    s_lshl_b32 s58, s38, 10
    s_add_u32 s58, s58, 12582912
    s_add_u32 s56, s45, 1
    s_and_b32 s56, s56, 3
    s_and_b32 s39, s45, 4
    s_or_b32 s56, s56, s39
    s_lshl_b32 s56, s56, 13
    s_and_b32 s38, s3, 3
    s_lshr_b32 s39, s3, 2
    s_lshl_b32 s55, s6, 3
    s_add_u32 s55, s55, s45
    s_lshl_b32 s55, s55, 2
    s_add_u32 s55, s55, s38
    s_lshl_b32 s55, s55, 5
    s_add_u32 s55, s55, s44
    s_lshl_b32 s55, s55, 1
    s_add_u32 s55, s55, s39
    s_lshl_b32 s55, s55, 10
    s_add_u32 s55, s55, 8388608
    s_lshl_b32 s59, s6, 4
    s_add_u32 s59, s59, s46
    s_lshl_b32 s59, s59, 11
    s_add_u32 s59, s59, 12648448
    v_and_b32 v148, 15, v1
    v_lshlrev_b32 v148, 7, v148
    v_and_b32 v149, 3, v1
    v_lshlrev_b32 v149, 2, v149
    v_bfe_u32 v136, v1, 2, 3
    v_lshl_add_u32 v149, v136, 7, v149
    s_lshl_b32 s39, s39, 13
    v_add_u32 v152, s39, v2
    v_add_u32 v153, 0x10000, v152
    v_and_b32 v136, 15, v1
    v_lshlrev_b32 v136, 4, v136
    v_lshrrev_b32 v137, 5, v1
    v_lshl_add_u32 v136, v137, 8, v136
    v_add_u32 v136, s39, v136
    v_add_u32 v136, 16384, v136
    v_add_u32 v137, 4, v1
    v_and_b32 v137, 8, v137
    v_lshlrev_b32 v137, 3, v137
    v_add_u32 v137, 139264, v137
    v_and_b32 v138, 11, v1
    v_cmp_eq_u32 vcc, 0, v138
    v_add_u32 v138, 16, v137
    s_nop 0
    v_cndmask_b32 v137, v138, v137, vcc
    v_and_b32 v138, 16, v1
    v_cmp_eq_u32 vcc, 0, v138
    v_mov_b32 v138, 0x8000
    s_nop 0
    v_cndmask_b32 v154, v137, v136, vcc
    v_cndmask_b32 v138, 0, v138, vcc
    v_add_u32 v155, v154, v138
    v_add_u32 v156, v155, v138
    v_add_u32 v157, v156, v138
    v_mov_b32 v104, 0
    v_mov_b32 v105, 0
    v_mov_b32 v106, 0
    v_mov_b32 v107, 0
    v_mov_b32 v108, 0
    v_mov_b32 v109, 0
    v_mov_b32 v110, 0
    v_mov_b32 v111, 0
    v_mov_b32 v112, 0
    v_mov_b32 v113, 0
    v_mov_b32 v114, 0
    v_mov_b32 v115, 0
    v_mov_b32 v116, 0
    v_mov_b32 v117, 0
    v_mov_b32 v118, 0
    v_mov_b32 v119, 0
    v_mov_b32 v120, 0
    v_mov_b32 v121, 0
    v_mov_b32 v122, 0
    v_mov_b32 v123, 0
    v_mov_b32 v124, 0
    v_mov_b32 v125, 0
    v_mov_b32 v126, 0
    v_mov_b32 v127, 0
    v_mov_b32 v128, 0
    v_mov_b32 v129, 0
    v_mov_b32 v130, 0
    v_mov_b32 v131, 0
    v_mov_b32 v132, 0
    v_mov_b32 v133, 0
    v_mov_b32 v134, 0
    v_mov_b32 v135, 0
    v_lshrrev_b32 v136, 3, v1
    v_bfe_u32 v137, v1, 4, 1
    v_lshlrev_b32 v137, 2, v137
    v_and_b32 v138, 7, v1
    v_xor_b32 v137, v137, v138
    v_lshlrev_b32 v137, 4, v137
    v_lshl_add_u32 v141, v136, 10, v137
    v_lshrrev_b32 v136, 5, v1
    v_lshlrev_b32 v137, 9, v136
    v_bfe_u32 v138, v1, 2, 2
    v_lshl_add_u32 v137, v138, 7, v137
    v_bfe_u32 v138, v1, 3, 1
    v_lshl_add_u32 v137, v138, 6, v137
    v_bfe_u32 v138, v1, 4, 1
    v_lshl_add_u32 v137, v138, 5, v137
    v_and_b32 v138, 3, v1
    v_lshl_add_u32 v142, v138, 3, v137
    v_xor_b32 v143, 64, v142
    v_and_b32 v144, 31, v1
    v_lshlrev_b32 v144, 11, v144
    v_lshl_add_u32 v144, v136, 4, v144
    s_lshl_b32 s20, s6, 4
    s_add_u32 s20, s20, s46
    s_lshl_b32 s20, s20, 2
    s_add_u32 s20, s20, s3
    s_lshl_b32 s20, s20, 15
    s_add_u32 s20, s20, 8388608
    s_lshl_b32 s21, s46, 18
    s_lshl_b32 s38, s3, 16
    s_add_u32 s21, s21, s38
    s_lshl_b32 s38, s6, 10
    s_add_u32 s21, s21, s38
    s_lshl_b32 s38, s47, 7
    s_add_u32 s21, s21, s38
    s_lshl_b32 s22, s6, 3
    s_add_u32 s22, s22, s45
    s_lshl_b32 s22, s22, 12
    s_lshl_b32 s38, s44, 7
    s_add_u32 s22, s22, s38
    s_add_u32 s22, s22, 12648448
    v_mov_b32 v140, 147460
    s_lshl_b32 s38, s3, 11
    v_add_u32 v12, s38, v2
    s_waitcnt lgkmcnt(0)
    s_barrier
    v_add_u32 v12, 147456, v12
    ds_read_b128 v[64:67], v12
    ds_read_b128 v[68:71], v12 offset:1024
    s_branch L_qkv_done
L_qkv_compute:
    v_and_b32 v16, 31, v1
    v_lshrrev_b32 v17, 5, v1
    v_bfe_u32 v18, v1, 1, 3
    v_xor_b32 v18, v18, v17
    v_lshlrev_b32 v18, 4, v18
    v_lshl_add_u32 v18, v16, 7, v18
    v_add_u32 v4, s50, v18
    v_xor_b32 v5, 32, v4
    v_xor_b32 v6, 64, v4
    v_xor_b32 v7, 96, v4
    v_add_u32 v8, 0x10000, v4
    v_add_u32 v9, 0x10000, v5
    v_add_u32 v10, 0x10000, v6
    v_add_u32 v11, 0x10000, v7
    v_lshlrev_b32 v19, 9, v17
    v_bfe_u32 v20, v1, 2, 2
    v_lshl_add_u32 v19, v20, 6, v19
    v_bfe_u32 v20, v1, 4, 1
    v_lshl_add_u32 v19, v20, 5, v19
    v_and_b32 v20, 3, v1
    v_lshl_add_u32 v19, v20, 3, v19
    v_add_u32 v12, 98304, v19
    v_bfe_u32 v19, v1, 2, 1
    v_bfe_u32 v20, v1, 3, 1
    v_xor_b32 v19, v19, v20
    v_mul_u32_u24 v19, 192, v19
    v_xor_b32 v13, v2, v19
    v_and_b32 v19, 15, v1
    v_lshlrev_b32 v19, 4, v19
    v_lshl_add_u32 v19, v17, 8, v19
    v_bfe_u32 v20, v1, 4, 1
    v_lshl_add_u32 v14, v20, 16, v19
    v_lshl_add_u32 v15, v20, 13, v19
    s_lshl_b32 s38, s3, 11
    v_add_u32 v15, s38, v15
    v_add_u32 v146, s38, v13
    v_add_u32 v147, s38, v2
    v_add_u32 v147, 155648, v147
    s_and_b32 s46, s4, 3
    s_lshl_b32 s46, s46, 2
    s_lshr_b32 s38, s5, 3
    s_add_u32 s46, s46, s38
    s_and_b32 s47, s5, 7
    s_lshl_b32 s38, s6, 4
    s_add_u32 s38, s38, s44
    s_lshl_b32 s54, s38, 17
    s_lshl_b32 s57, s3, 10
    s_add_u32 s54, s54, s57
    s_lshl_b32 s58, s38, 10
    s_add_u32 s58, s58, 12582912
    s_add_u32 s56, s45, 1
    s_and_b32 s56, s56, 3
    s_and_b32 s39, s45, 4
    s_or_b32 s56, s56, s39
    s_lshl_b32 s56, s56, 13
    s_and_b32 s38, s3, 3
    s_lshr_b32 s39, s3, 2
    s_lshl_b32 s55, s6, 3
    s_add_u32 s55, s55, s45
    s_lshl_b32 s55, s55, 2
    s_add_u32 s55, s55, s38
    s_lshl_b32 s55, s55, 5
    s_add_u32 s55, s55, s44
    s_lshl_b32 s55, s55, 1
    s_add_u32 s55, s55, s39
    s_lshl_b32 s55, s55, 10
    s_add_u32 s55, s55, 8388608
    s_lshl_b32 s59, s6, 4
    s_add_u32 s59, s59, s46
    s_lshl_b32 s59, s59, 11
    s_add_u32 s59, s59, 12648448
    v_and_b32 v148, 15, v1
    v_lshlrev_b32 v148, 7, v148
    v_and_b32 v149, 3, v1
    v_lshlrev_b32 v149, 2, v149
    v_bfe_u32 v136, v1, 2, 3
    v_lshl_add_u32 v149, v136, 7, v149
    s_lshl_b32 s39, s39, 13
    v_add_u32 v152, s39, v2
    v_add_u32 v153, 0x10000, v152
    v_and_b32 v136, 15, v1
    v_lshlrev_b32 v136, 4, v136
    v_lshrrev_b32 v137, 5, v1
    v_lshl_add_u32 v136, v137, 8, v136
    v_add_u32 v136, s39, v136
    v_add_u32 v136, 16384, v136
    v_add_u32 v137, 4, v1
    v_and_b32 v137, 8, v137
    v_lshlrev_b32 v137, 3, v137
    v_add_u32 v137, 139264, v137
    v_and_b32 v138, 11, v1
    v_cmp_eq_u32 vcc, 0, v138
    v_add_u32 v138, 16, v137
    s_nop 0
    v_cndmask_b32 v137, v138, v137, vcc
    v_and_b32 v138, 16, v1
    v_cmp_eq_u32 vcc, 0, v138
    v_mov_b32 v138, 0x8000
    s_nop 0
    v_cndmask_b32 v154, v137, v136, vcc
    v_cndmask_b32 v138, 0, v138, vcc
    v_add_u32 v155, v154, v138
    v_add_u32 v156, v155, v138
    v_add_u32 v157, v156, v138
    v_mov_b32 v104, 0
    v_mov_b32 v105, 0
    v_mov_b32 v106, 0
    v_mov_b32 v107, 0
    v_mov_b32 v108, 0
    v_mov_b32 v109, 0
    v_mov_b32 v110, 0
    v_mov_b32 v111, 0
    v_mov_b32 v112, 0
    v_mov_b32 v113, 0
    v_mov_b32 v114, 0
    v_mov_b32 v115, 0
    v_mov_b32 v116, 0
    v_mov_b32 v117, 0
    v_mov_b32 v118, 0
    v_mov_b32 v119, 0
    v_mov_b32 v120, 0
    v_mov_b32 v121, 0
    v_mov_b32 v122, 0
    v_mov_b32 v123, 0
    v_mov_b32 v124, 0
    v_mov_b32 v125, 0
    v_mov_b32 v126, 0
    v_mov_b32 v127, 0
    v_mov_b32 v128, 0
    v_mov_b32 v129, 0
    v_mov_b32 v130, 0
    v_mov_b32 v131, 0
    v_mov_b32 v132, 0
    v_mov_b32 v133, 0
    v_mov_b32 v134, 0
    v_mov_b32 v135, 0
    v_lshrrev_b32 v136, 3, v1
    v_bfe_u32 v137, v1, 4, 1
    v_lshlrev_b32 v137, 2, v137
    v_and_b32 v138, 7, v1
    v_xor_b32 v137, v137, v138
    v_lshlrev_b32 v137, 4, v137
    v_lshl_add_u32 v141, v136, 10, v137
    s_lshl_b32 s48, s45, 13
    s_add_u32 s48, s48, s54
    s_add_u32 s48, s48, s57
    s_waitcnt lgkmcnt(0)
    s_mov_b32 s8, s34
    s_mov_b32 s9, s35
    v_lshrrev_b32 v136, 5, v1
    v_lshlrev_b32 v137, 9, v136
    v_bfe_u32 v138, v1, 2, 2
    v_lshl_add_u32 v137, v138, 7, v137
    v_bfe_u32 v138, v1, 3, 1
    v_lshl_add_u32 v137, v138, 6, v137
    v_bfe_u32 v138, v1, 4, 1
    v_lshl_add_u32 v137, v138, 5, v137
    v_and_b32 v138, 3, v1
    v_lshl_add_u32 v142, v138, 3, v137
    v_xor_b32 v143, 64, v142
    v_and_b32 v144, 31, v1
    v_lshlrev_b32 v144, 11, v144
    v_lshl_add_u32 v144, v136, 4, v144
    s_lshl_b32 s20, s6, 4
    s_add_u32 s20, s20, s46
    s_lshl_b32 s20, s20, 2
    s_add_u32 s20, s20, s3
    s_lshl_b32 s20, s20, 15
    s_add_u32 s20, s20, 8388608
    s_lshl_b32 s21, s46, 18
    s_lshl_b32 s38, s3, 16
    s_add_u32 s21, s21, s38
    s_lshl_b32 s38, s6, 10
    s_add_u32 s21, s21, s38
    s_lshl_b32 s38, s47, 7
    s_add_u32 s21, s21, s38
    s_lshl_b32 s22, s6, 3
    s_add_u32 s22, s22, s45
    s_lshl_b32 s22, s22, 12
    s_lshl_b32 s38, s44, 7
    s_add_u32 s22, s22, s38
    s_add_u32 s22, s22, 12648448
    v_mov_b32 v140, 147460
    s_mov_b32 s12, s32
    s_mov_b32 s13, s33
    s_mov_b32 s14, 256
    s_mov_b32 s15, 0x20000
    s_cmp_lg_u32 s2, 0
    s_cbranch_scc1 L_notag
    s_cmp_lg_u32 s3, 0
    s_cbranch_scc1 L_notag
    s_memrealtime s[38:39]
    s_waitcnt lgkmcnt(0)
    s_or_b32 s38, s38, 1
    v_mov_b32 v16, s38
    v_mov_b32 v17, 0
    buffer_store_dword v16, v17, s[12:15], 0 offen sc1
L_notag:
    s_cmp_eq_u32 s6, 0
    s_cselect_b64 s[30:31], s[24:25], s[30:31]
    s_barrier
    ds_read_b128 v[16:19], v4 offset:0
    ds_read_b64_tr_b16 v[44:45], v12 offset:1024
    ds_read_b64_tr_b16 v[46:47], v12 offset:1280
    ds_read_b128 v[20:23], v4 offset:4096
    ds_read_b64_tr_b16 v[48:49], v12 offset:2048
    ds_read_b64_tr_b16 v[50:51], v12 offset:2304
    ds_read_b64_tr_b16 v[40:41], v12 offset:0
    ds_read_b64_tr_b16 v[42:43], v12 offset:256
    s_waitcnt lgkmcnt(5)
    v_mfma_f32_32x32x16_bf16 v[160:175], v[44:47], v[16:19], 0
    ds_read_b128 v[24:27], v5 offset:0
    ds_read_b64_tr_b16 v[56:57], v12 offset:4096
    s_waitcnt lgkmcnt(6)
    v_mfma_f32_32x32x16_bf16 v[176:191], v[44:47], v[20:23], 0
    ds_read_b64_tr_b16 v[58:59], v12 offset:4352
    ds_read_b128 v[28:31], v5 offset:4096
    s_waitcnt lgkmcnt(6)
    v_mfma_f32_32x32x16_bf16 v[192:207], v[16:19], v[48:51], 0
    ds_read_b64_tr_b16 v[60:61], v12 offset:5120
    ds_read_b64_tr_b16 v[62:63], v12 offset:5376
    v_mfma_f32_32x32x16_bf16 v[208:223], v[20:23], v[48:51], 0
    ds_read_b64_tr_b16 v[52:53], v12 offset:3072
    ds_read_b64_tr_b16 v[54:55], v12 offset:3328
    s_waitcnt lgkmcnt(8)
    v_mfma_f32_32x32x16_bf16 v[224:239], v[40:43], v[16:19], 0
    v_mfma_f32_32x32x16_bf16 v[240:255], v[40:43], v[20:23], 0
    s_waitcnt lgkmcnt(5)
    v_mfma_f32_32x32x16_bf16 v[160:175], v[56:59], v[24:27], v[160:175]
    ds_read_b128 v[16:19], v6 offset:0
    ds_read_b64_tr_b16 v[44:45], v12 offset:7168
    s_waitcnt lgkmcnt(6)
    v_mfma_f32_32x32x16_bf16 v[176:191], v[56:59], v[28:31], v[176:191]
    ds_read_b64_tr_b16 v[46:47], v12 offset:7424
    ds_read_b128 v[20:23], v6 offset:4096
    s_waitcnt lgkmcnt(6)
    v_mfma_f32_32x32x16_bf16 v[192:207], v[24:27], v[60:63], v[192:207]
    ds_read_b64_tr_b16 v[48:49], v12 offset:8192
    ds_read_b64_tr_b16 v[50:51], v12 offset:8448
    v_mfma_f32_32x32x16_bf16 v[208:223], v[28:31], v[60:63], v[208:223]
    ds_read_b64_tr_b16 v[40:41], v12 offset:6144
    ds_read_b64_tr_b16 v[42:43], v12 offset:6400
    s_waitcnt lgkmcnt(8)
    v_mfma_f32_32x32x16_bf16 v[224:239], v[52:55], v[24:27], v[224:239]
    v_mfma_f32_32x32x16_bf16 v[240:255], v[52:55], v[28:31], v[240:255]
    s_waitcnt lgkmcnt(5)
    v_mfma_f32_32x32x16_bf16 v[160:175], v[44:47], v[16:19], v[160:175]
    ds_read_b128 v[24:27], v7 offset:0
    ds_read_b64_tr_b16 v[56:57], v12 offset:10240
    s_waitcnt lgkmcnt(6)
    v_mfma_f32_32x32x16_bf16 v[176:191], v[44:47], v[20:23], v[176:191]
    ds_read_b64_tr_b16 v[58:59], v12 offset:10496
    ds_read_b128 v[28:31], v7 offset:4096
    s_waitcnt lgkmcnt(6)
    v_mfma_f32_32x32x16_bf16 v[192:207], v[16:19], v[48:51], v[192:207]
    ds_read_b64_tr_b16 v[60:61], v12 offset:11264
    ds_read_b64_tr_b16 v[62:63], v12 offset:11520
    v_mfma_f32_32x32x16_bf16 v[208:223], v[20:23], v[48:51], v[208:223]
    ds_read_b64_tr_b16 v[52:53], v12 offset:9216
    ds_read_b64_tr_b16 v[54:55], v12 offset:9472
    s_waitcnt lgkmcnt(8)
    v_mfma_f32_32x32x16_bf16 v[224:239], v[40:43], v[16:19], v[224:239]
    v_mfma_f32_32x32x16_bf16 v[240:255], v[40:43], v[20:23], v[240:255]
    s_waitcnt lgkmcnt(5)
    v_mfma_f32_32x32x16_bf16 v[160:175], v[56:59], v[24:27], v[160:175]
    s_waitcnt lgkmcnt(0)
    s_barrier
    ds_read_b128 v[16:19], v4 offset:32768
    ds_read_b64_tr_b16 v[44:45], v12 offset:13312
    v_mfma_f32_32x32x16_bf16 v[176:191], v[56:59], v[28:31], v[176:191]
    ds_read_b64_tr_b16 v[46:47], v12 offset:13568
    ds_read_b128 v[20:23], v4 offset:36864
    v_mfma_f32_32x32x16_bf16 v[192:207], v[24:27], v[60:63], v[192:207]
    ds_read_b64_tr_b16 v[48:49], v12 offset:14336
    ds_read_b64_tr_b16 v[50:51], v12 offset:14592
    v_mfma_f32_32x32x16_bf16 v[208:223], v[28:31], v[60:63], v[208:223]
    ds_read_b64_tr_b16 v[40:41], v12 offset:12288
    ds_read_b64_tr_b16 v[42:43], v12 offset:12544
    v_mfma_f32_32x32x16_bf16 v[224:239], v[52:55], v[24:27], v[224:239]
    v_mfma_f32_32x32x16_bf16 v[240:255], v[52:55], v[28:31], v[240:255]
    s_waitcnt lgkmcnt(5)
    v_mfma_f32_32x32x16_bf16 v[160:175], v[44:47], v[16:19], v[160:175]
    ds_read_b128 v[24:27], v5 offset:32768
    ds_read_b64_tr_b16 v[56:57], v12 offset:16384
    s_waitcnt lgkmcnt(6)
    v_mfma_f32_32x32x16_bf16 v[176:191], v[44:47], v[20:23], v[176:191]
    ds_read_b64_tr_b16 v[58:59], v12 offset:16640
    ds_read_b128 v[28:31], v5 offset:36864
    s_waitcnt lgkmcnt(6)
    v_mfma_f32_32x32x16_bf16 v[192:207], v[16:19], v[48:51], v[192:207]
    ds_read_b64_tr_b16 v[60:61], v12 offset:17408
    ds_read_b64_tr_b16 v[62:63], v12 offset:17664
    v_mfma_f32_32x32x16_bf16 v[208:223], v[20:23], v[48:51], v[208:223]
    ds_read_b64_tr_b16 v[52:53], v12 offset:15360
    ds_read_b64_tr_b16 v[54:55], v12 offset:15616
    s_waitcnt lgkmcnt(8)
    v_mfma_f32_32x32x16_bf16 v[224:239], v[40:43], v[16:19], v[224:239]
    v_mfma_f32_32x32x16_bf16 v[240:255], v[40:43], v[20:23], v[240:255]
    s_waitcnt lgkmcnt(5)
    v_mfma_f32_32x32x16_bf16 v[160:175], v[56:59], v[24:27], v[160:175]
    ds_read_b128 v[16:19], v6 offset:32768
    ds_read_b64_tr_b16 v[44:45], v12 offset:19456
    s_waitcnt lgkmcnt(6)
    v_mfma_f32_32x32x16_bf16 v[176:191], v[56:59], v[28:31], v[176:191]
    ds_read_b64_tr_b16 v[46:47], v12 offset:19712
    ds_read_b128 v[20:23], v6 offset:36864
    s_waitcnt lgkmcnt(6)
    v_mfma_f32_32x32x16_bf16 v[192:207], v[24:27], v[60:63], v[192:207]
    ds_read_b64_tr_b16 v[48:49], v12 offset:20480
    ds_read_b64_tr_b16 v[50:51], v12 offset:20736
    v_mfma_f32_32x32x16_bf16 v[208:223], v[28:31], v[60:63], v[208:223]
    ds_read_b64_tr_b16 v[40:41], v12 offset:18432
    ds_read_b64_tr_b16 v[42:43], v12 offset:18688
    s_waitcnt lgkmcnt(8)
    v_mfma_f32_32x32x16_bf16 v[224:239], v[52:55], v[24:27], v[224:239]
    v_mfma_f32_32x32x16_bf16 v[240:255], v[52:55], v[28:31], v[240:255]
    s_waitcnt lgkmcnt(5)
    v_mfma_f32_32x32x16_bf16 v[160:175], v[44:47], v[16:19], v[160:175]
    ds_read_b128 v[24:27], v7 offset:32768
    ds_read_b64_tr_b16 v[56:57], v12 offset:22528
    s_waitcnt lgkmcnt(6)
    v_mfma_f32_32x32x16_bf16 v[176:191], v[44:47], v[20:23], v[176:191]
    ds_read_b64_tr_b16 v[58:59], v12 offset:22784
    ds_read_b128 v[28:31], v7 offset:36864
    s_waitcnt lgkmcnt(6)
    v_mfma_f32_32x32x16_bf16 v[192:207], v[16:19], v[48:51], v[192:207]
    ds_read_b64_tr_b16 v[60:61], v12 offset:23552
    ds_read_b64_tr_b16 v[62:63], v12 offset:23808
    v_mfma_f32_32x32x16_bf16 v[208:223], v[20:23], v[48:51], v[208:223]
    ds_read_b64_tr_b16 v[52:53], v12 offset:21504
    ds_read_b64_tr_b16 v[54:55], v12 offset:21760
    s_waitcnt lgkmcnt(8)
    v_mfma_f32_32x32x16_bf16 v[224:239], v[40:43], v[16:19], v[224:239]
    v_mfma_f32_32x32x16_bf16 v[240:255], v[40:43], v[20:23], v[240:255]
    s_waitcnt lgkmcnt(5)
    v_mfma_f32_32x32x16_bf16 v[160:175], v[56:59], v[24:27], v[160:175]
    s_waitcnt lgkmcnt(0)
    s_barrier
    ds_read_b128 v[16:19], v8 offset:0
    ds_read_b64_tr_b16 v[44:45], v12 offset:25600
    v_mfma_f32_32x32x16_bf16 v[176:191], v[56:59], v[28:31], v[176:191]
    ds_read_b64_tr_b16 v[46:47], v12 offset:25856
    ds_read_b128 v[20:23], v8 offset:4096
    v_mfma_f32_32x32x16_bf16 v[192:207], v[24:27], v[60:63], v[192:207]
    ds_read_b64_tr_b16 v[48:49], v12 offset:26624
    ds_read_b64_tr_b16 v[50:51], v12 offset:26880
    v_mfma_f32_32x32x16_bf16 v[208:223], v[28:31], v[60:63], v[208:223]
    ds_read_b64_tr_b16 v[40:41], v12 offset:24576
    ds_read_b64_tr_b16 v[42:43], v12 offset:24832
    v_mfma_f32_32x32x16_bf16 v[224:239], v[52:55], v[24:27], v[224:239]
    v_mfma_f32_32x32x16_bf16 v[240:255], v[52:55], v[28:31], v[240:255]
    s_waitcnt lgkmcnt(5)
    v_mfma_f32_32x32x16_bf16 v[160:175], v[44:47], v[16:19], v[160:175]
    ds_read_b128 v[24:27], v9 offset:0
    ds_read_b64_tr_b16 v[56:57], v12 offset:28672
    s_waitcnt lgkmcnt(6)
    v_mfma_f32_32x32x16_bf16 v[176:191], v[44:47], v[20:23], v[176:191]
    ds_read_b64_tr_b16 v[58:59], v12 offset:28928
    ds_read_b128 v[28:31], v9 offset:4096
    s_waitcnt lgkmcnt(6)
    v_mfma_f32_32x32x16_bf16 v[192:207], v[16:19], v[48:51], v[192:207]
    ds_read_b64_tr_b16 v[60:61], v12 offset:29696
    ds_read_b64_tr_b16 v[62:63], v12 offset:29952
    v_mfma_f32_32x32x16_bf16 v[208:223], v[20:23], v[48:51], v[208:223]
    ds_read_b64_tr_b16 v[52:53], v12 offset:27648
    ds_read_b64_tr_b16 v[54:55], v12 offset:27904
    s_waitcnt lgkmcnt(8)
    v_mfma_f32_32x32x16_bf16 v[224:239], v[40:43], v[16:19], v[224:239]
    v_mfma_f32_32x32x16_bf16 v[240:255], v[40:43], v[20:23], v[240:255]
    s_waitcnt lgkmcnt(5)
    v_mfma_f32_32x32x16_bf16 v[160:175], v[56:59], v[24:27], v[160:175]
    ds_read_b128 v[16:19], v10 offset:0
    ds_read_b64_tr_b16 v[44:45], v12 offset:31744
    s_waitcnt lgkmcnt(6)
    v_mfma_f32_32x32x16_bf16 v[176:191], v[56:59], v[28:31], v[176:191]
    ds_read_b64_tr_b16 v[46:47], v12 offset:32000
    ds_read_b128 v[20:23], v10 offset:4096
    s_waitcnt lgkmcnt(6)
    v_mfma_f32_32x32x16_bf16 v[192:207], v[24:27], v[60:63], v[192:207]
    ds_read_b64_tr_b16 v[48:49], v12 offset:32768
    ds_read_b64_tr_b16 v[50:51], v12 offset:33024
    v_mfma_f32_32x32x16_bf16 v[208:223], v[28:31], v[60:63], v[208:223]
    ds_read_b64_tr_b16 v[40:41], v12 offset:30720
    ds_read_b64_tr_b16 v[42:43], v12 offset:30976
    s_waitcnt lgkmcnt(8)
    v_mfma_f32_32x32x16_bf16 v[224:239], v[52:55], v[24:27], v[224:239]
    v_mfma_f32_32x32x16_bf16 v[240:255], v[52:55], v[28:31], v[240:255]
    s_waitcnt lgkmcnt(5)
    v_mfma_f32_32x32x16_bf16 v[160:175], v[44:47], v[16:19], v[160:175]
    ds_read_b128 v[24:27], v11 offset:0
    ds_read_b64_tr_b16 v[56:57], v12 offset:34816
    s_waitcnt lgkmcnt(6)
    v_mfma_f32_32x32x16_bf16 v[176:191], v[44:47], v[20:23], v[176:191]
    ds_read_b64_tr_b16 v[58:59], v12 offset:35072
    ds_read_b128 v[28:31], v11 offset:4096
    s_waitcnt lgkmcnt(6)
    v_mfma_f32_32x32x16_bf16 v[192:207], v[16:19], v[48:51], v[192:207]
    ds_read_b64_tr_b16 v[60:61], v12 offset:35840
    ds_read_b64_tr_b16 v[62:63], v12 offset:36096
    v_mfma_f32_32x32x16_bf16 v[208:223], v[20:23], v[48:51], v[208:223]
    ds_read_b64_tr_b16 v[52:53], v12 offset:33792
    ds_read_b64_tr_b16 v[54:55], v12 offset:34048
    s_waitcnt lgkmcnt(8)
    v_mfma_f32_32x32x16_bf16 v[224:239], v[40:43], v[16:19], v[224:239]
    v_mfma_f32_32x32x16_bf16 v[240:255], v[40:43], v[20:23], v[240:255]
    s_waitcnt lgkmcnt(5)
    v_mfma_f32_32x32x16_bf16 v[160:175], v[56:59], v[24:27], v[160:175]
    s_waitcnt lgkmcnt(0)
    s_barrier
    ds_read_b128 v[16:19], v4 offset:0
    ds_read_b64_tr_b16 v[44:45], v12 offset:1024
    v_mfma_f32_32x32x16_bf16 v[176:191], v[56:59], v[28:31], v[176:191]
    ds_read_b64_tr_b16 v[46:47], v12 offset:1280
    ds_read_b128 v[20:23], v4 offset:4096
    v_mfma_f32_32x32x16_bf16 v[192:207], v[24:27], v[60:63], v[192:207]
    ds_read_b64_tr_b16 v[48:49], v12 offset:2048
    ds_read_b64_tr_b16 v[50:51], v12 offset:2304
    v_mfma_f32_32x32x16_bf16 v[208:223], v[28:31], v[60:63], v[208:223]
    ds_read_b64_tr_b16 v[40:41], v12 offset:0
    ds_read_b64_tr_b16 v[42:43], v12 offset:256
    v_mfma_f32_32x32x16_bf16 v[224:239], v[52:55], v[24:27], v[224:239]
    v_mfma_f32_32x32x16_bf16 v[240:255], v[52:55], v[28:31], v[240:255]
    s_waitcnt lgkmcnt(5)
    v_mfma_f32_32x32x16_bf16 v[160:175], v[44:47], v[16:19], v[160:175]
    ds_read_b128 v[24:27], v5 offset:0
    ds_read_b64_tr_b16 v[56:57], v12 offset:4096
    s_waitcnt lgkmcnt(6)
    v_mfma_f32_32x32x16_bf16 v[176:191], v[44:47], v[20:23], v[176:191]
    ds_read_b64_tr_b16 v[58:59], v12 offset:4352
    ds_read_b128 v[28:31], v5 offset:4096
    s_waitcnt lgkmcnt(6)
    v_mfma_f32_32x32x16_bf16 v[192:207], v[16:19], v[48:51], v[192:207]
    ds_read_b64_tr_b16 v[60:61], v12 offset:5120
    ds_read_b64_tr_b16 v[62:63], v12 offset:5376
    v_mfma_f32_32x32x16_bf16 v[208:223], v[20:23], v[48:51], v[208:223]
    ds_read_b64_tr_b16 v[52:53], v12 offset:3072
    ds_read_b64_tr_b16 v[54:55], v12 offset:3328
    s_waitcnt lgkmcnt(8)
    v_mfma_f32_32x32x16_bf16 v[224:239], v[40:43], v[16:19], v[224:239]
    v_mfma_f32_32x32x16_bf16 v[240:255], v[40:43], v[20:23], v[240:255]
    s_waitcnt lgkmcnt(5)
    v_mfma_f32_32x32x16_bf16 v[160:175], v[56:59], v[24:27], v[160:175]
    ds_read_b128 v[16:19], v6 offset:0
    ds_read_b64_tr_b16 v[44:45], v12 offset:7168
    s_waitcnt lgkmcnt(6)
    v_mfma_f32_32x32x16_bf16 v[176:191], v[56:59], v[28:31], v[176:191]
    ds_read_b64_tr_b16 v[46:47], v12 offset:7424
    ds_read_b128 v[20:23], v6 offset:4096
    s_waitcnt lgkmcnt(6)
    v_mfma_f32_32x32x16_bf16 v[192:207], v[24:27], v[60:63], v[192:207]
    ds_read_b64_tr_b16 v[48:49], v12 offset:8192
    ds_read_b64_tr_b16 v[50:51], v12 offset:8448
    v_mfma_f32_32x32x16_bf16 v[208:223], v[28:31], v[60:63], v[208:223]
    ds_read_b64_tr_b16 v[40:41], v12 offset:6144
    ds_read_b64_tr_b16 v[42:43], v12 offset:6400
    s_waitcnt lgkmcnt(8)
    v_mfma_f32_32x32x16_bf16 v[224:239], v[52:55], v[24:27], v[224:239]
    v_mfma_f32_32x32x16_bf16 v[240:255], v[52:55], v[28:31], v[240:255]
    s_waitcnt lgkmcnt(5)
    v_mfma_f32_32x32x16_bf16 v[160:175], v[44:47], v[16:19], v[160:175]
    ds_read_b128 v[24:27], v7 offset:0
    ds_read_b64_tr_b16 v[56:57], v12 offset:10240
    s_waitcnt lgkmcnt(6)
    v_mfma_f32_32x32x16_bf16 v[176:191], v[44:47], v[20:23], v[176:191]
    ds_read_b64_tr_b16 v[58:59], v12 offset:10496
    ds_read_b128 v[28:31], v7 offset:4096
    s_waitcnt lgkmcnt(6)
    v_mfma_f32_32x32x16_bf16 v[192:207], v[16:19], v[48:51], v[192:207]
    ds_read_b64_tr_b16 v[60:61], v12 offset:11264
    ds_read_b64_tr_b16 v[62:63], v12 offset:11520
    v_mfma_f32_32x32x16_bf16 v[208:223], v[20:23], v[48:51], v[208:223]
    ds_read_b64_tr_b16 v[52:53], v12 offset:9216
    ds_read_b64_tr_b16 v[54:55], v12 offset:9472
    s_waitcnt lgkmcnt(8)
    v_mfma_f32_32x32x16_bf16 v[224:239], v[40:43], v[16:19], v[224:239]
    v_mfma_f32_32x32x16_bf16 v[240:255], v[40:43], v[20:23], v[240:255]
    s_waitcnt lgkmcnt(5)
    v_mfma_f32_32x32x16_bf16 v[160:175], v[56:59], v[24:27], v[160:175]
    s_waitcnt lgkmcnt(0)
    s_barrier
    ds_read_b128 v[16:19], v4 offset:32768
    ds_read_b64_tr_b16 v[44:45], v12 offset:13312
    v_mfma_f32_32x32x16_bf16 v[176:191], v[56:59], v[28:31], v[176:191]
    ds_read_b64_tr_b16 v[46:47], v12 offset:13568
    ds_read_b128 v[20:23], v4 offset:36864
    v_mfma_f32_32x32x16_bf16 v[192:207], v[24:27], v[60:63], v[192:207]
    ds_read_b64_tr_b16 v[48:49], v12 offset:14336
    ds_read_b64_tr_b16 v[50:51], v12 offset:14592
    v_mfma_f32_32x32x16_bf16 v[208:223], v[28:31], v[60:63], v[208:223]
    ds_read_b64_tr_b16 v[40:41], v12 offset:12288
    ds_read_b64_tr_b16 v[42:43], v12 offset:12544
    v_mfma_f32_32x32x16_bf16 v[224:239], v[52:55], v[24:27], v[224:239]
    v_mfma_f32_32x32x16_bf16 v[240:255], v[52:55], v[28:31], v[240:255]
    s_waitcnt lgkmcnt(5)
    v_mfma_f32_32x32x16_bf16 v[160:175], v[44:47], v[16:19], v[160:175]
    ds_read_b128 v[24:27], v5 offset:32768
    ds_read_b64_tr_b16 v[56:57], v12 offset:16384
    s_waitcnt lgkmcnt(6)
    v_mfma_f32_32x32x16_bf16 v[176:191], v[44:47], v[20:23], v[176:191]
    ds_read_b64_tr_b16 v[58:59], v12 offset:16640
    ds_read_b128 v[28:31], v5 offset:36864
    s_waitcnt lgkmcnt(6)
    v_mfma_f32_32x32x16_bf16 v[192:207], v[16:19], v[48:51], v[192:207]
    ds_read_b64_tr_b16 v[60:61], v12 offset:17408
    ds_read_b64_tr_b16 v[62:63], v12 offset:17664
    v_mfma_f32_32x32x16_bf16 v[208:223], v[20:23], v[48:51], v[208:223]
    ds_read_b64_tr_b16 v[52:53], v12 offset:15360
    ds_read_b64_tr_b16 v[54:55], v12 offset:15616
    s_waitcnt lgkmcnt(8)
    v_mfma_f32_32x32x16_bf16 v[224:239], v[40:43], v[16:19], v[224:239]
    v_mfma_f32_32x32x16_bf16 v[240:255], v[40:43], v[20:23], v[240:255]
    s_waitcnt lgkmcnt(5)
    v_mfma_f32_32x32x16_bf16 v[160:175], v[56:59], v[24:27], v[160:175]
    ds_read_b128 v[16:19], v6 offset:32768
    ds_read_b64_tr_b16 v[44:45], v12 offset:19456
    s_waitcnt lgkmcnt(6)
    v_mfma_f32_32x32x16_bf16 v[176:191], v[56:59], v[28:31], v[176:191]
    ds_read_b64_tr_b16 v[46:47], v12 offset:19712
    ds_read_b128 v[20:23], v6 offset:36864
    s_waitcnt lgkmcnt(6)
    v_mfma_f32_32x32x16_bf16 v[192:207], v[24:27], v[60:63], v[192:207]
    ds_read_b64_tr_b16 v[48:49], v12 offset:20480
    ds_read_b64_tr_b16 v[50:51], v12 offset:20736
    v_mfma_f32_32x32x16_bf16 v[208:223], v[28:31], v[60:63], v[208:223]
    ds_read_b64_tr_b16 v[40:41], v12 offset:18432
    ds_read_b64_tr_b16 v[42:43], v12 offset:18688
    s_waitcnt lgkmcnt(8)
    v_mfma_f32_32x32x16_bf16 v[224:239], v[52:55], v[24:27], v[224:239]
    v_mfma_f32_32x32x16_bf16 v[240:255], v[52:55], v[28:31], v[240:255]
    s_waitcnt lgkmcnt(5)
    v_mfma_f32_32x32x16_bf16 v[160:175], v[44:47], v[16:19], v[160:175]
    ds_read_b128 v[24:27], v7 offset:32768
    ds_read_b64_tr_b16 v[56:57], v12 offset:22528
    s_waitcnt lgkmcnt(6)
    v_mfma_f32_32x32x16_bf16 v[176:191], v[44:47], v[20:23], v[176:191]
    ds_read_b64_tr_b16 v[58:59], v12 offset:22784
    ds_read_b128 v[28:31], v7 offset:36864
    s_waitcnt lgkmcnt(6)
    v_mfma_f32_32x32x16_bf16 v[192:207], v[16:19], v[48:51], v[192:207]
    ds_read_b64_tr_b16 v[60:61], v12 offset:23552
    ds_read_b64_tr_b16 v[62:63], v12 offset:23808
    v_mfma_f32_32x32x16_bf16 v[208:223], v[20:23], v[48:51], v[208:223]
    ds_read_b64_tr_b16 v[52:53], v12 offset:21504
    ds_read_b64_tr_b16 v[54:55], v12 offset:21760
    s_waitcnt lgkmcnt(8)
    v_mfma_f32_32x32x16_bf16 v[224:239], v[40:43], v[16:19], v[224:239]
    v_mfma_f32_32x32x16_bf16 v[240:255], v[40:43], v[20:23], v[240:255]
    s_waitcnt lgkmcnt(5)
    v_mfma_f32_32x32x16_bf16 v[160:175], v[56:59], v[24:27], v[160:175]
    s_waitcnt lgkmcnt(0)
    s_barrier
    ds_read_b128 v[16:19], v8 offset:0
    ds_read_b64_tr_b16 v[44:45], v12 offset:25600
    v_mfma_f32_32x32x16_bf16 v[176:191], v[56:59], v[28:31], v[176:191]
    ds_read_b64_tr_b16 v[46:47], v12 offset:25856
    ds_read_b128 v[20:23], v8 offset:4096
    v_mfma_f32_32x32x16_bf16 v[192:207], v[24:27], v[60:63], v[192:207]
    ds_read_b64_tr_b16 v[48:49], v12 offset:26624
    ds_read_b64_tr_b16 v[50:51], v12 offset:26880
    v_mfma_f32_32x32x16_bf16 v[208:223], v[28:31], v[60:63], v[208:223]
    ds_read_b64_tr_b16 v[40:41], v12 offset:24576
    ds_read_b64_tr_b16 v[42:43], v12 offset:24832
    v_mfma_f32_32x32x16_bf16 v[224:239], v[52:55], v[24:27], v[224:239]
    v_mfma_f32_32x32x16_bf16 v[240:255], v[52:55], v[28:31], v[240:255]
    s_waitcnt lgkmcnt(5)
    v_mfma_f32_32x32x16_bf16 v[160:175], v[44:47], v[16:19], v[160:175]
    ds_read_b128 v[24:27], v9 offset:0
    ds_read_b64_tr_b16 v[56:57], v12 offset:28672
    s_waitcnt lgkmcnt(6)
    v_mfma_f32_32x32x16_bf16 v[176:191], v[44:47], v[20:23], v[176:191]
    ds_read_b64_tr_b16 v[58:59], v12 offset:28928
    ds_read_b128 v[28:31], v9 offset:4096
    s_waitcnt lgkmcnt(6)
    v_mfma_f32_32x32x16_bf16 v[192:207], v[16:19], v[48:51], v[192:207]
    ds_read_b64_tr_b16 v[60:61], v12 offset:29696
    ds_read_b64_tr_b16 v[62:63], v12 offset:29952
    v_mfma_f32_32x32x16_bf16 v[208:223], v[20:23], v[48:51], v[208:223]
    ds_read_b64_tr_b16 v[52:53], v12 offset:27648
    ds_read_b64_tr_b16 v[54:55], v12 offset:27904
    s_waitcnt lgkmcnt(8)
    v_mfma_f32_32x32x16_bf16 v[224:239], v[40:43], v[16:19], v[224:239]
    v_mfma_f32_32x32x16_bf16 v[240:255], v[40:43], v[20:23], v[240:255]
    s_waitcnt lgkmcnt(5)
    v_mfma_f32_32x32x16_bf16 v[160:175], v[56:59], v[24:27], v[160:175]
    ds_read_b128 v[16:19], v10 offset:0
    ds_read_b64_tr_b16 v[44:45], v12 offset:31744
    s_waitcnt lgkmcnt(6)
    v_mfma_f32_32x32x16_bf16 v[176:191], v[56:59], v[28:31], v[176:191]
    ds_read_b64_tr_b16 v[46:47], v12 offset:32000
    ds_read_b128 v[20:23], v10 offset:4096
    s_waitcnt lgkmcnt(6)
    v_mfma_f32_32x32x16_bf16 v[192:207], v[24:27], v[60:63], v[192:207]
    ds_read_b64_tr_b16 v[48:49], v12 offset:32768
    ds_read_b64_tr_b16 v[50:51], v12 offset:33024
    v_mfma_f32_32x32x16_bf16 v[208:223], v[28:31], v[60:63], v[208:223]
    ds_read_b64_tr_b16 v[40:41], v12 offset:30720
    ds_read_b64_tr_b16 v[42:43], v12 offset:30976
    s_waitcnt lgkmcnt(8)
    v_mfma_f32_32x32x16_bf16 v[224:239], v[52:55], v[24:27], v[224:239]
    v_mfma_f32_32x32x16_bf16 v[240:255], v[52:55], v[28:31], v[240:255]
    s_waitcnt lgkmcnt(5)
    v_mfma_f32_32x32x16_bf16 v[160:175], v[44:47], v[16:19], v[160:175]
    ds_read_b128 v[24:27], v11 offset:0
    ds_read_b64_tr_b16 v[56:57], v12 offset:34816
    s_waitcnt lgkmcnt(6)
    v_mfma_f32_32x32x16_bf16 v[176:191], v[44:47], v[20:23], v[176:191]
    ds_read_b64_tr_b16 v[58:59], v12 offset:35072
    ds_read_b128 v[28:31], v11 offset:4096
    s_waitcnt lgkmcnt(6)
    v_mfma_f32_32x32x16_bf16 v[192:207], v[16:19], v[48:51], v[192:207]
    ds_read_b64_tr_b16 v[60:61], v12 offset:35840
    ds_read_b64_tr_b16 v[62:63], v12 offset:36096
    v_mfma_f32_32x32x16_bf16 v[208:223], v[20:23], v[48:51], v[208:223]
    ds_read_b64_tr_b16 v[52:53], v12 offset:33792
    ds_read_b64_tr_b16 v[54:55], v12 offset:34048
    s_waitcnt lgkmcnt(8)
    v_mfma_f32_32x32x16_bf16 v[224:239], v[40:43], v[16:19], v[224:239]
    v_mfma_f32_32x32x16_bf16 v[240:255], v[40:43], v[20:23], v[240:255]
    s_waitcnt lgkmcnt(5)
    v_mfma_f32_32x32x16_bf16 v[160:175], v[56:59], v[24:27], v[160:175]
    s_waitcnt lgkmcnt(0)
    s_barrier
    ds_read_b128 v[16:19], v4 offset:0
    ds_read_b64_tr_b16 v[44:45], v12 offset:1024
    v_mfma_f32_32x32x16_bf16 v[176:191], v[56:59], v[28:31], v[176:191]
    ds_read_b64_tr_b16 v[46:47], v12 offset:1280
    ds_read_b128 v[20:23], v4 offset:4096
    v_mfma_f32_32x32x16_bf16 v[192:207], v[24:27], v[60:63], v[192:207]
    ds_read_b64_tr_b16 v[48:49], v12 offset:2048
    ds_read_b64_tr_b16 v[50:51], v12 offset:2304
    v_mfma_f32_32x32x16_bf16 v[208:223], v[28:31], v[60:63], v[208:223]
    ds_read_b64_tr_b16 v[40:41], v12 offset:0
    ds_read_b64_tr_b16 v[42:43], v12 offset:256
    v_mfma_f32_32x32x16_bf16 v[224:239], v[52:55], v[24:27], v[224:239]
    v_mfma_f32_32x32x16_bf16 v[240:255], v[52:55], v[28:31], v[240:255]
    s_waitcnt lgkmcnt(5)
    v_mfma_f32_32x32x16_bf16 v[160:175], v[44:47], v[16:19], v[160:175]
    ds_read_b128 v[24:27], v5 offset:0
    ds_read_b64_tr_b16 v[56:57], v12 offset:4096
    s_waitcnt lgkmcnt(6)
    v_mfma_f32_32x32x16_bf16 v[176:191], v[44:47], v[20:23], v[176:191]
    ds_read_b64_tr_b16 v[58:59], v12 offset:4352
    ds_read_b128 v[28:31], v5 offset:4096
    s_waitcnt lgkmcnt(6)
    v_mfma_f32_32x32x16_bf16 v[192:207], v[16:19], v[48:51], v[192:207]
    ds_read_b64_tr_b16 v[60:61], v12 offset:5120
    ds_read_b64_tr_b16 v[62:63], v12 offset:5376
    v_mfma_f32_32x32x16_bf16 v[208:223], v[20:23], v[48:51], v[208:223]
    ds_read_b64_tr_b16 v[52:53], v12 offset:3072
    ds_read_b64_tr_b16 v[54:55], v12 offset:3328
    s_waitcnt lgkmcnt(8)
    v_mfma_f32_32x32x16_bf16 v[224:239], v[40:43], v[16:19], v[224:239]
    v_mfma_f32_32x32x16_bf16 v[240:255], v[40:43], v[20:23], v[240:255]
    s_waitcnt lgkmcnt(5)
    v_mfma_f32_32x32x16_bf16 v[160:175], v[56:59], v[24:27], v[160:175]
    ds_read_b128 v[64:67], v6 offset:0
    ds_read_b64_tr_b16 v[44:45], v12 offset:7168
    s_waitcnt lgkmcnt(6)
    v_mfma_f32_32x32x16_bf16 v[176:191], v[56:59], v[28:31], v[176:191]
    ds_read_b64_tr_b16 v[46:47], v12 offset:7424
    ds_read_b128 v[68:71], v6 offset:4096
    s_waitcnt lgkmcnt(6)
    v_mfma_f32_32x32x16_bf16 v[192:207], v[24:27], v[60:63], v[192:207]
    ds_read_b64_tr_b16 v[48:49], v12 offset:8192
    ds_read_b64_tr_b16 v[50:51], v12 offset:8448
    v_mfma_f32_32x32x16_bf16 v[208:223], v[28:31], v[60:63], v[208:223]
    ds_read_b64_tr_b16 v[32:33], v12 offset:6144
    ds_read_b64_tr_b16 v[34:35], v12 offset:6400
    s_waitcnt lgkmcnt(8)
    v_mfma_f32_32x32x16_bf16 v[224:239], v[52:55], v[24:27], v[224:239]
    v_mfma_f32_32x32x16_bf16 v[240:255], v[52:55], v[28:31], v[240:255]
    s_waitcnt lgkmcnt(5)
    v_mfma_f32_32x32x16_bf16 v[160:175], v[44:47], v[64:67], v[160:175]
    ds_read_b128 v[72:75], v7 offset:0
    ds_read_b64_tr_b16 v[56:57], v12 offset:10240
    s_waitcnt lgkmcnt(6)
    v_mfma_f32_32x32x16_bf16 v[176:191], v[44:47], v[68:71], v[176:191]
    ds_read_b64_tr_b16 v[58:59], v12 offset:10496
    ds_read_b128 v[76:79], v7 offset:4096
    s_waitcnt lgkmcnt(6)
    v_mfma_f32_32x32x16_bf16 v[192:207], v[64:67], v[48:51], v[192:207]
    ds_read_b64_tr_b16 v[60:61], v12 offset:11264
    ds_read_b64_tr_b16 v[62:63], v12 offset:11520
    v_mfma_f32_32x32x16_bf16 v[208:223], v[68:71], v[48:51], v[208:223]
    ds_read_b64_tr_b16 v[36:37], v12 offset:9216
    ds_read_b64_tr_b16 v[38:39], v12 offset:9472
    s_waitcnt lgkmcnt(5)
    v_mfma_f32_32x32x16_bf16 v[160:175], v[56:59], v[72:75], v[160:175]
    s_waitcnt lgkmcnt(0)
    s_barrier
    ds_read_b128 v[80:83], v4 offset:32768
    ds_read_b64_tr_b16 v[44:45], v12 offset:13312
    v_mfma_f32_32x32x16_bf16 v[176:191], v[56:59], v[76:79], v[176:191]
    ds_read_b64_tr_b16 v[46:47], v12 offset:13568
    ds_read_b128 v[84:87], v4 offset:36864
    v_mfma_f32_32x32x16_bf16 v[192:207], v[72:75], v[60:63], v[192:207]
    ds_read_b64_tr_b16 v[48:49], v12 offset:14336
    ds_read_b64_tr_b16 v[50:51], v12 offset:14592
    v_mfma_f32_32x32x16_bf16 v[208:223], v[76:79], v[60:63], v[208:223]
    ds_read_b64_tr_b16 v[96:97], v12 offset:12288
    ds_read_b64_tr_b16 v[98:99], v12 offset:12544
    s_waitcnt lgkmcnt(5)
    v_mfma_f32_32x32x16_bf16 v[160:175], v[44:47], v[80:83], v[160:175]
    ds_read_b128 v[88:91], v5 offset:32768
    ds_read_b64_tr_b16 v[56:57], v12 offset:16384
    s_waitcnt lgkmcnt(6)
    v_mfma_f32_32x32x16_bf16 v[176:191], v[44:47], v[84:87], v[176:191]
    ds_read_b64_tr_b16 v[58:59], v12 offset:16640
    ds_read_b128 v[92:95], v5 offset:36864
    s_waitcnt lgkmcnt(6)
    v_mfma_f32_32x32x16_bf16 v[192:207], v[80:83], v[48:51], v[192:207]
    ds_read_b64_tr_b16 v[60:61], v12 offset:17408
    ds_read_b64_tr_b16 v[62:63], v12 offset:17664
    v_mfma_f32_32x32x16_bf16 v[208:223], v[84:87], v[48:51], v[208:223]
    ds_read_b64_tr_b16 v[100:101], v12 offset:15360
    ds_read_b64_tr_b16 v[102:103], v12 offset:15616
    s_waitcnt lgkmcnt(5)
    v_mfma_f32_32x32x16_bf16 v[160:175], v[56:59], v[88:91], v[160:175]
    ds_read_b128 v[16:19], v6 offset:32768
    ds_read_b64_tr_b16 v[44:45], v12 offset:19456
    s_waitcnt lgkmcnt(6)
    v_mfma_f32_32x32x16_bf16 v[176:191], v[56:59], v[92:95], v[176:191]
    ds_read_b64_tr_b16 v[46:47], v12 offset:19712
    ds_read_b128 v[20:23], v6 offset:36864
    s_waitcnt lgkmcnt(6)
    v_mfma_f32_32x32x16_bf16 v[192:207], v[88:91], v[60:63], v[192:207]
    ds_read_b64_tr_b16 v[48:49], v12 offset:20480
    ds_read_b64_tr_b16 v[50:51], v12 offset:20736
    v_mfma_f32_32x32x16_bf16 v[208:223], v[92:95], v[60:63], v[208:223]
    ds_read_b64_tr_b16 v[40:41], v12 offset:18432
    ds_read_b64_tr_b16 v[42:43], v12 offset:18688
    s_waitcnt lgkmcnt(5)
    v_mfma_f32_32x32x16_bf16 v[160:175], v[44:47], v[16:19], v[160:175]
    ds_read_b128 v[24:27], v7 offset:32768
    ds_read_b64_tr_b16 v[56:57], v12 offset:22528
    s_waitcnt lgkmcnt(6)
    v_mfma_f32_32x32x16_bf16 v[176:191], v[44:47], v[20:23], v[176:191]
    ds_read_b64_tr_b16 v[58:59], v12 offset:22784
    ds_read_b128 v[28:31], v7 offset:36864
    s_waitcnt lgkmcnt(6)
    v_mfma_f32_32x32x16_bf16 v[192:207], v[16:19], v[48:51], v[192:207]
    ds_read_b64_tr_b16 v[60:61], v12 offset:23552
    ds_read_b64_tr_b16 v[62:63], v12 offset:23808
    v_mfma_f32_32x32x16_bf16 v[208:223], v[20:23], v[48:51], v[208:223]
    ds_read_b64_tr_b16 v[52:53], v12 offset:21504
    ds_read_b64_tr_b16 v[54:55], v12 offset:21760
    s_waitcnt lgkmcnt(5)
    v_mfma_f32_32x32x16_bf16 v[160:175], v[56:59], v[24:27], v[160:175]
    s_waitcnt lgkmcnt(4)
    v_mfma_f32_32x32x16_bf16 v[176:191], v[56:59], v[28:31], v[176:191]
    s_waitcnt lgkmcnt(2)
    v_mfma_f32_32x32x16_bf16 v[192:207], v[24:27], v[60:63], v[192:207]
    v_mfma_f32_32x32x16_bf16 v[208:223], v[28:31], v[60:63], v[208:223]
L_gemm_end:
    s_mov_b32 s38, 0x3eb8aa3b
    s_mov_b32 s39, s38
    s_waitcnt lgkmcnt(0)
    v_mfma_f32_32x32x16_bf16 v[224:239], v[32:35], v[64:67], v[224:239]
    s_nop 3
    v_mfma_f32_32x32x16_bf16 v[240:255], v[32:35], v[68:71], v[240:255]
    s_nop 1
    v_cvt_pk_bf16_f32 v44, v160, v161
    v_cvt_pk_bf16_f32 v45, v162, v163
    v_cvt_pk_bf16_f32 v46, v164, v165
    v_cvt_pk_bf16_f32 v47, v166, v167
    v_mfma_f32_32x32x16_bf16 v[224:239], v[36:39], v[72:75], v[224:239]
    s_add_u32 s40, s48, 0
    buffer_store_dwordx4 v[44:47], v13, s[8:11], s40 offen offset:0 sc1
    v_mfma_f32_32x32x16_bf16 v[240:255], v[36:39], v[76:79], v[240:255]
    ds_write_b128 v146, v[44:47] offset:0
    v_cvt_pk_bf16_f32 v48, v168, v169
    v_cvt_pk_bf16_f32 v49, v170, v171
    v_cvt_pk_bf16_f32 v50, v172, v173
    v_cvt_pk_bf16_f32 v51, v174, v175
    v_mfma_f32_32x32x16_bf16 v[224:239], v[96:99], v[80:83], v[224:239]
    s_add_u32 s40, s48, 65536
    buffer_store_dwordx4 v[48:51], v13, s[8:11], s40 offen offset:0 sc1
    v_mfma_f32_32x32x16_bf16 v[240:255], v[96:99], v[84:87], v[240:255]
    ds_write_b128 v146, v[48:51] offset:8192
    v_cvt_pk_bf16_f32 v56, v176, v177
    v_cvt_pk_bf16_f32 v57, v178, v179
    v_cvt_pk_bf16_f32 v58, v180, v181
    v_cvt_pk_bf16_f32 v59, v182, v183
    v_mfma_f32_32x32x16_bf16 v[224:239], v[100:103], v[88:91], v[224:239]
    s_add_u32 s40, s48, 0
    buffer_store_dwordx4 v[56:59], v13, s[8:11], s40 offen offset:1024 sc1
    v_mfma_f32_32x32x16_bf16 v[240:255], v[100:103], v[92:95], v[240:255]
    ds_write_b128 v146, v[56:59] offset:1024
    v_cvt_pk_bf16_f32 v60, v184, v185
    v_cvt_pk_bf16_f32 v61, v186, v187
    v_cvt_pk_bf16_f32 v62, v188, v189
    v_cvt_pk_bf16_f32 v63, v190, v191
    v_mfma_f32_32x32x16_bf16 v[224:239], v[40:43], v[16:19], v[224:239]
    s_add_u32 s40, s48, 65536
    buffer_store_dwordx4 v[60:63], v13, s[8:11], s40 offen offset:1024 sc1
    v_mfma_f32_32x32x16_bf16 v[240:255], v[40:43], v[20:23], v[240:255]
    ds_write_b128 v146, v[60:63] offset:9216
    v_cvt_pk_bf16_f32 v44, v192, v193
    v_cvt_pk_bf16_f32 v45, v194, v195
    v_cvt_pk_bf16_f32 v46, v196, v197
    v_cvt_pk_bf16_f32 v47, v198, v199
    v_mfma_f32_32x32x16_bf16 v[224:239], v[52:55], v[24:27], v[224:239]
    s_add_u32 s40, s48, 4194304
    buffer_store_dwordx4 v[44:47], v14, s[8:11], s40 offen offset:0 sc1
    v_mfma_f32_32x32x16_bf16 v[240:255], v[52:55], v[28:31], v[240:255]
    ds_write_b128 v15, v[44:47] offset:16384
    v_cvt_pk_bf16_f32 v48, v200, v201
    v_cvt_pk_bf16_f32 v49, v202, v203
    v_cvt_pk_bf16_f32 v50, v204, v205
    v_cvt_pk_bf16_f32 v51, v206, v207
    s_add_u32 s40, s48, 4194304
    buffer_store_dwordx4 v[48:51], v14, s[8:11], s40 offen offset:512 sc1
    ds_write_b128 v15, v[48:51] offset:16896
    v_cvt_pk_bf16_f32 v56, v208, v209
    v_cvt_pk_bf16_f32 v57, v210, v211
    v_cvt_pk_bf16_f32 v58, v212, v213
    v_cvt_pk_bf16_f32 v59, v214, v215
    s_add_u32 s40, s48, 4194304
    buffer_store_dwordx4 v[56:59], v14, s[8:11], s40 offen offset:1024 sc1
    ds_write_b128 v15, v[56:59] offset:17408
    v_cvt_pk_bf16_f32 v60, v216, v217
    v_cvt_pk_bf16_f32 v61, v218, v219
    v_cvt_pk_bf16_f32 v62, v220, v221
    v_cvt_pk_bf16_f32 v63, v222, v223
    s_add_u32 s40, s48, 4194304
    buffer_store_dwordx4 v[60:63], v14, s[8:11], s40 offen offset:1536 sc1
    ds_write_b128 v15, v[60:63] offset:17920
    v_pk_mul_f32 v[232:233], v[232:233], s[38:39]
    v_pk_mul_f32 v[234:235], v[234:235], s[38:39]
    v_pk_mul_f32 v[236:237], v[236:237], s[38:39]
    v_pk_mul_f32 v[238:239], v[238:239], s[38:39]
    v_cvt_pk_bf16_f32 v44, v232, v233
    v_cvt_pk_bf16_f32 v45, v234, v235
    v_cvt_pk_bf16_f32 v46, v236, v237
    v_cvt_pk_bf16_f32 v47, v238, v239
    ds_write_b128 v147, v[44:47] offset:0
    v_pk_mul_f32 v[248:249], v[248:249], s[38:39]
    v_pk_mul_f32 v[250:251], v[250:251], s[38:39]
    v_pk_mul_f32 v[252:253], v[252:253], s[38:39]
    v_pk_mul_f32 v[254:255], v[254:255], s[38:39]
    v_cvt_pk_bf16_f32 v48, v248, v249
    v_cvt_pk_bf16_f32 v49, v250, v251
    v_cvt_pk_bf16_f32 v50, v252, v253
    v_cvt_pk_bf16_f32 v51, v254, v255
    ds_write_b128 v147, v[48:51] offset:1024
    v_pk_mul_f32 v[224:225], v[224:225], s[38:39]
    v_pk_mul_f32 v[226:227], v[226:227], s[38:39]
    v_pk_mul_f32 v[228:229], v[228:229], s[38:39]
    v_pk_mul_f32 v[230:231], v[230:231], s[38:39]
    v_cvt_pk_bf16_f32 v64, v224, v225
    v_cvt_pk_bf16_f32 v65, v226, v227
    v_cvt_pk_bf16_f32 v66, v228, v229
    v_cvt_pk_bf16_f32 v67, v230, v231
    v_pk_mul_f32 v[240:241], v[240:241], s[38:39]
    v_pk_mul_f32 v[242:243], v[242:243], s[38:39]
    v_pk_mul_f32 v[244:245], v[244:245], s[38:39]
    v_pk_mul_f32 v[246:247], v[246:247], s[38:39]
    v_cvt_pk_bf16_f32 v68, v240, v241
    v_cvt_pk_bf16_f32 v69, v242, v243
    v_cvt_pk_bf16_f32 v70, v244, v245
    v_cvt_pk_bf16_f32 v71, v246, v247
    s_waitcnt lgkmcnt(0)
    s_barrier
L_qkv_done:
    ds_read_b128 v[40:43], v152
    v_mov_b32 v145, 147456
    ds_read_b128 v[48:51], v154
    ds_read_b128 v[52:55], v154 offset:512
    ds_read_b32 v145, v145
    v_mov_b32 v5, 0xdddddddd
    s_mov_b32 s51, 0x5f800000
    s_lshl_b32 s50, s3, 13
    s_lshl_b32 s38, s47, 7
    s_add_u32 s50, s50, s38
    s_waitcnt lgkmcnt(3)
    v_mfma_f32_32x32x16_bf16 v[72:87], v[40:43], v[64:67], 0
    v_mfma_f32_32x32x16_bf16 v[88:103], v[40:43], v[68:71], 0
    s_mov_b64 s[16:17], s[30:31]
    s_mov_b32 s18, 524288
    s_mov_b32 s19, 0x20000
    s_nop 7
    v_max3_f32 v136, v72, v73, v74
    v_max3_f32 v136, v75, v76, v136
    v_max3_f32 v136, v77, v78, v136
    v_max3_f32 v136, v79, v80, v136
    v_max3_f32 v136, v81, v82, v136
    v_max3_f32 v136, v83, v84, v136
    v_max3_f32 v136, v85, v86, v136
    v_max_f32 v136, v87, v136
    v_max3_f32 v137, v88, v89, v90
    v_max3_f32 v137, v91, v92, v137
    v_max3_f32 v137, v93, v94, v137
    v_max3_f32 v137, v95, v96, v137
    v_max3_f32 v137, v97, v98, v137
    v_max3_f32 v137, v99, v100, v137
    v_max3_f32 v137, v101, v102, v137
    v_max_f32 v137, v103, v137
    v_mov_b32 v138, v136
    v_mov_b32 v139, v137
    s_nop 0
    v_permlane32_swap_b32 v138, v136
    v_permlane32_swap_b32 v139, v137
    s_nop 0
    v_max_f32 v136, v138, v136
    v_max_f32 v137, v139, v137
    v_sub_f32 v72, 0, v136
    v_sub_f32 v73, 0, v136
    v_pk_mov_b32 v[74:75], v[72:73], v[72:73]
    v_pk_mov_b32 v[76:77], v[72:73], v[72:73]
    v_pk_mov_b32 v[78:79], v[72:73], v[72:73]
    v_pk_mov_b32 v[80:81], v[72:73], v[72:73]
    v_pk_mov_b32 v[82:83], v[72:73], v[72:73]
    v_pk_mov_b32 v[84:85], v[72:73], v[72:73]
    v_pk_mov_b32 v[86:87], v[72:73], v[72:73]
    s_nop 1
    v_mfma_f32_32x32x16_bf16 v[8:23], v[40:43], v[64:67], v[72:87]
    v_sub_f32 v88, 0, v137
    v_sub_f32 v89, 0, v137
    v_pk_mov_b32 v[90:91], v[88:89], v[88:89]
    v_pk_mov_b32 v[92:93], v[88:89], v[88:89]
    v_pk_mov_b32 v[94:95], v[88:89], v[88:89]
    v_pk_mov_b32 v[96:97], v[88:89], v[88:89]
    v_pk_mov_b32 v[98:99], v[88:89], v[88:89]
    v_pk_mov_b32 v[100:101], v[88:89], v[88:89]
    v_pk_mov_b32 v[102:103], v[88:89], v[88:89]
    s_waitcnt lgkmcnt(0)
    v_readfirstlane_b32 s7, v145
    s_nop 0
    s_setprio 1
    v_exp_f32 v8, v8
    v_exp_f32 v9, v9
    ds_read_b128 v[44:47], v152 offset:1024
    v_exp_f32 v10, v10
    v_exp_f32 v11, v11
    v_exp_f32 v12, v12
    v_mfma_f32_32x32x16_bf16 v[24:39], v[40:43], v[68:71], v[88:103]
    ds_read_b128 v[56:59], v154 offset:1024
    v_exp_f32 v13, v13
    v_exp_f32 v14, v14
    v_exp_f32 v15, v15
    v_exp_f32 v16, v16
    v_exp_f32 v17, v17
    v_smfmac_f32_32x32x32_bf16 v[104:119], v[48:51], v[8:15], v5
    ds_read_b128 v[60:63], v154 offset:1536
    v_exp_f32 v18, v18
    v_exp_f32 v19, v19
    v_exp_f32 v20, v20
    v_exp_f32 v21, v21
    v_exp_f32 v22, v22
    v_exp_f32 v23, v23
    v_exp_f32 v24, v24
    v_exp_f32 v25, v25
    v_smfmac_f32_32x32x32_bf16 v[104:119], v[52:55], v[16:23], v5
    s_add_u32 s52, s54, s56
    s_add_u32 s53, s52, 65536
    v_exp_f32 v26, v26
    v_exp_f32 v27, v27
    v_exp_f32 v28, v28
    s_waitcnt lgkmcnt(0)
    v_mfma_f32_32x32x16_bf16 v[8:23], v[44:47], v[64:67], v[72:87]
    s_add_u32 s48, s52, 4194304
    v_exp_f32 v29, v29
    v_exp_f32 v30, v30
    v_exp_f32 v31, v31
    v_exp_f32 v32, v32
    v_exp_f32 v33, v33
    v_smfmac_f32_32x32x32_bf16 v[120:135], v[48:51], v[24:31], v5
    s_add_u32 s49, s52, 4259840
    s_add_u32 s43, s56, 0x2000
    v_exp_f32 v34, v34
    v_exp_f32 v35, v35
    v_exp_f32 v36, v36
    v_exp_f32 v37, v37
    v_exp_f32 v38, v38
    v_exp_f32 v39, v39
    v_exp_f32 v8, v8
    v_exp_f32 v9, v9
    v_smfmac_f32_32x32x32_bf16 v[120:135], v[52:55], v[32:39], v5
    ds_read_b128 v[40:43], v152 offset:2048
    v_exp_f32 v10, v10
    v_exp_f32 v11, v11
    v_exp_f32 v12, v12
    v_mfma_f32_32x32x16_bf16 v[24:39], v[44:47], v[68:71], v[88:103]
    ds_read_b128 v[48:51], v154 offset:2048
    v_exp_f32 v13, v13
    v_exp_f32 v14, v14
    v_exp_f32 v15, v15
    v_exp_f32 v16, v16
    v_exp_f32 v17, v17
    v_smfmac_f32_32x32x32_bf16 v[104:119], v[56:59], v[8:15], v5
    ds_read_b128 v[52:55], v154 offset:2560
    v_exp_f32 v18, v18
    v_exp_f32 v19, v19
    v_exp_f32 v20, v20
    v_exp_f32 v21, v21
    v_exp_f32 v22, v22
    v_exp_f32 v23, v23
    v_exp_f32 v24, v24
    v_exp_f32 v25, v25
    v_smfmac_f32_32x32x32_bf16 v[104:119], v[60:63], v[16:23], v5
    s_and_b32 s43, s43, 0x6000
    s_and_b32 s56, s56, 0x8000
    v_exp_f32 v26, v26
    v_exp_f32 v27, v27
    v_exp_f32 v28, v28
    s_waitcnt lgkmcnt(0)
    v_mfma_f32_32x32x16_bf16 v[8:23], v[40:43], v[64:67], v[72:87]
    s_or_b32 s56, s56, s43
    v_exp_f32 v29, v29
    v_exp_f32 v30, v30
    v_exp_f32 v31, v31
    v_exp_f32 v32, v32
    v_exp_f32 v33, v33
    v_smfmac_f32_32x32x32_bf16 v[120:135], v[56:59], v[24:31], v5
    v_exp_f32 v34, v34
    v_exp_f32 v35, v35
    v_exp_f32 v36, v36
    v_exp_f32 v37, v37
    v_exp_f32 v38, v38
    v_exp_f32 v39, v39
    v_exp_f32 v8, v8
    v_exp_f32 v9, v9
    v_smfmac_f32_32x32x32_bf16 v[120:135], v[60:63], v[32:39], v5
    ds_read_b128 v[44:47], v152 offset:3072
    v_exp_f32 v10, v10
    v_exp_f32 v11, v11
    v_exp_f32 v12, v12
    v_mfma_f32_32x32x16_bf16 v[24:39], v[40:43], v[68:71], v[88:103]
    ds_read_b128 v[56:59], v154 offset:3072
    v_exp_f32 v13, v13
    v_exp_f32 v14, v14
    v_exp_f32 v15, v15
    v_exp_f32 v16, v16
    v_exp_f32 v17, v17
    v_smfmac_f32_32x32x32_bf16 v[104:119], v[48:51], v[8:15], v5
    ds_read_b128 v[60:63], v154 offset:3584
    v_exp_f32 v18, v18
    v_exp_f32 v19, v19
    v_exp_f32 v20, v20
    v_exp_f32 v21, v21
    v_exp_f32 v22, v22
    v_exp_f32 v23, v23
    v_exp_f32 v24, v24
    v_exp_f32 v25, v25
    v_smfmac_f32_32x32x32_bf16 v[104:119], v[52:55], v[16:23], v5
    s_cmp_ge_u32 s3, 4
    s_cbranch_scc1 L_attn_noflag
    s_lshl_b32 s38, s45, 7
    s_lshl_b32 s40, s3, 2
    s_add_u32 s38, s38, s40
    s_add_u32 s40, s38, s58
    s_waitcnt vmcnt(0)
    v_mov_b32 v136, s7
    v_mov_b32 v137, 0
    s_mov_b64 exec, 1
    buffer_store_dword v136, v137, s[8:11], s40 offen sc1
    s_mov_b64 exec, -1
L_attn_noflag:
    v_exp_f32 v26, v26
    v_exp_f32 v27, v27
    v_exp_f32 v28, v28
    s_waitcnt lgkmcnt(0)
    v_mfma_f32_32x32x16_bf16 v[8:23], v[44:47], v[64:67], v[72:87]
    v_exp_f32 v29, v29
    v_exp_f32 v30, v30
    v_exp_f32 v31, v31
    v_exp_f32 v32, v32
    v_exp_f32 v33, v33
    v_smfmac_f32_32x32x32_bf16 v[120:135], v[48:51], v[24:31], v5
    v_exp_f32 v34, v34
    v_exp_f32 v35, v35
    v_exp_f32 v36, v36
    v_exp_f32 v37, v37
    v_exp_f32 v38, v38
    v_exp_f32 v39, v39
    v_exp_f32 v8, v8
    v_exp_f32 v9, v9
    v_smfmac_f32_32x32x32_bf16 v[120:135], v[52:55], v[32:39], v5
    ds_read_b128 v[40:43], v152 offset:4096
    v_exp_f32 v10, v10
    v_exp_f32 v11, v11
    v_exp_f32 v12, v12
    v_mfma_f32_32x32x16_bf16 v[24:39], v[44:47], v[68:71], v[88:103]
    ds_read_b128 v[48:51], v154 offset:4096
    v_exp_f32 v13, v13
    v_exp_f32 v14, v14
    v_exp_f32 v15, v15
    v_exp_f32 v16, v16
    v_exp_f32 v17, v17
    v_smfmac_f32_32x32x32_bf16 v[104:119], v[56:59], v[8:15], v5
    ds_read_b128 v[52:55], v154 offset:4608
    v_exp_f32 v18, v18
    v_exp_f32 v19, v19
    v_exp_f32 v20, v20
    v_exp_f32 v21, v21
    v_exp_f32 v22, v22
    v_exp_f32 v23, v23
    v_exp_f32 v24, v24
    v_exp_f32 v25, v25
    v_smfmac_f32_32x32x32_bf16 v[104:119], v[60:63], v[16:23], v5
    v_exp_f32 v26, v26
    v_exp_f32 v27, v27
    v_exp_f32 v28, v28
    s_waitcnt lgkmcnt(0)
    v_mfma_f32_32x32x16_bf16 v[8:23], v[40:43], v[64:67], v[72:87]
    v_exp_f32 v29, v29
    v_exp_f32 v30, v30
    v_exp_f32 v31, v31
    v_exp_f32 v32, v32
    v_exp_f32 v33, v33
    v_smfmac_f32_32x32x32_bf16 v[120:135], v[56:59], v[24:31], v5
    v_exp_f32 v34, v34
    v_exp_f32 v35, v35
    v_exp_f32 v36, v36
    v_exp_f32 v37, v37
    v_exp_f32 v38, v38
    v_exp_f32 v39, v39
    v_exp_f32 v8, v8
    v_exp_f32 v9, v9
    v_smfmac_f32_32x32x32_bf16 v[120:135], v[60:63], v[32:39], v5
    ds_read_b128 v[44:47], v152 offset:5120
    v_exp_f32 v10, v10
    v_exp_f32 v11, v11
    v_exp_f32 v12, v12
    v_mfma_f32_32x32x16_bf16 v[24:39], v[40:43], v[68:71], v[88:103]
    ds_read_b128 v[56:59], v154 offset:5120
    v_exp_f32 v13, v13
    v_exp_f32 v14, v14
    v_exp_f32 v15, v15
    v_exp_f32 v16, v16
    v_exp_f32 v17, v17
    v_smfmac_f32_32x32x32_bf16 v[104:119], v[48:51], v[8:15], v5
    ds_read_b128 v[60:63], v154 offset:5632
    v_exp_f32 v18, v18
    v_exp_f32 v19, v19
    v_exp_f32 v20, v20
    v_exp_f32 v21, v21
    v_exp_f32 v22, v22
    v_exp_f32 v23, v23
    v_exp_f32 v24, v24
    v_exp_f32 v25, v25
    v_smfmac_f32_32x32x32_bf16 v[104:119], v[52:55], v[16:23], v5
    v_exp_f32 v26, v26
    v_exp_f32 v27, v27
    v_exp_f32 v28, v28
    s_waitcnt lgkmcnt(0)
    v_mfma_f32_32x32x16_bf16 v[8:23], v[44:47], v[64:67], v[72:87]
    v_exp_f32 v29, v29
    v_exp_f32 v30, v30
    v_exp_f32 v31, v31
    v_exp_f32 v32, v32
    v_exp_f32 v33, v33
    v_smfmac_f32_32x32x32_bf16 v[120:135], v[48:51], v[24:31], v5
    v_exp_f32 v34, v34
    v_exp_f32 v35, v35
    v_exp_f32 v36, v36
    v_exp_f32 v37, v37
    v_exp_f32 v38, v38
    v_exp_f32 v39, v39
    v_exp_f32 v8, v8
    v_exp_f32 v9, v9
    v_smfmac_f32_32x32x32_bf16 v[120:135], v[52:55], v[32:39], v5
    s_cmp_ge_u32 s3, 4
    s_cbranch_scc1 L_nopoll
    s_and_b32 s40, s45, 3
    s_lshl_b32 s40, s40, 2
    s_lshl_b32 s40, 0xff0, s40
    s_lshr_b32 s42, s40, 16
    s_or_b32 s40, s40, s42
    s_and_b32 s40, s40, 0xffff
    s_and_b32 s42, s45, 4
    s_lshl_b32 s42, s42, 2
    s_lshl_b32 s40, s40, s42
    s_mov_b32 s38, 0x40000
L_poll1:
    buffer_load_dword v136, v149, s[8:11], s58 offen sc1
    s_waitcnt vmcnt(0)
    v_cmp_ne_u32 vcc, s7, v136
    s_sub_u32 s38, s38, 1
    s_cbranch_scc1 L_poll1_x
    s_and_b32 s39, vcc_lo, s40
    s_cbranch_scc0 L_poll1_x
    s_sleep 2
    s_branch L_poll1
L_poll1_x:
    s_add_u32 m0, s57, 32768
    s_nop 0
    buffer_load_dwordx4 v2, s[8:11], s52 offen sc1 lds
    s_add_u32 m0, s57, 40960
    s_nop 0
    buffer_load_dwordx4 v2, s[8:11], s53 offen sc1 lds
    s_add_u32 m0, s57, 49152
    s_nop 0
    buffer_load_dwordx4 v2, s[8:11], s48 offen sc1 lds
    s_add_u32 m0, s57, 57344
    s_nop 0
    buffer_load_dwordx4 v2, s[8:11], s49 offen sc1 lds
    s_add_u32 m0, s57, 36864
    s_add_i32 s42, s52, 4096
    buffer_load_dwordx4 v2, s[8:11], s42 offen sc1 lds
    s_add_u32 m0, s57, 45056
    s_add_i32 s42, s53, 4096
    buffer_load_dwordx4 v2, s[8:11], s42 offen sc1 lds
    s_add_u32 m0, s57, 53248
    s_add_i32 s42, s48, 4096
    buffer_load_dwordx4 v2, s[8:11], s42 offen sc1 lds
    s_add_u32 m0, s57, 61440
    s_add_i32 s42, s49, 4096
    buffer_load_dwordx4 v2, s[8:11], s42 offen sc1 lds
L_nopoll:
    ds_read_b128 v[40:43], v152 offset:6144
    v_exp_f32 v10, v10
    v_exp_f32 v11, v11
    v_exp_f32 v12, v12
    v_mfma_f32_32x32x16_bf16 v[24:39], v[44:47], v[68:71], v[88:103]
    ds_read_b128 v[48:51], v154 offset:6144
    v_exp_f32 v13, v13
    v_exp_f32 v14, v14
    v_exp_f32 v15, v15
    v_exp_f32 v16, v16
    v_exp_f32 v17, v17
    v_smfmac_f32_32x32x32_bf16 v[104:119], v[56:59], v[8:15], v5
    ds_read_b128 v[52:55], v154 offset:6656
    v_exp_f32 v18, v18
    v_exp_f32 v19, v19
    v_exp_f32 v20, v20
    v_exp_f32 v21, v21
    v_exp_f32 v22, v22
    v_exp_f32 v23, v23
    v_exp_f32 v24, v24
    v_exp_f32 v25, v25
    v_smfmac_f32_32x32x32_bf16 v[104:119], v[60:63], v[16:23], v5
    v_exp_f32 v26, v26
    v_exp_f32 v27, v27
    v_exp_f32 v28, v28
    s_waitcnt lgkmcnt(0)
    v_mfma_f32_32x32x16_bf16 v[8:23], v[40:43], v[64:67], v[72:87]
    v_exp_f32 v29, v29
    v_exp_f32 v30, v30
    v_exp_f32 v31, v31
    v_exp_f32 v32, v32
    v_exp_f32 v33, v33
    v_smfmac_f32_32x32x32_bf16 v[120:135], v[56:59], v[24:31], v5
    v_exp_f32 v34, v34
    v_exp_f32 v35, v35
    v_exp_f32 v36, v36
    v_exp_f32 v37, v37
    v_exp_f32 v38, v38
    v_exp_f32 v39, v39
    v_exp_f32 v8, v8
    v_exp_f32 v9, v9
    v_smfmac_f32_32x32x32_bf16 v[120:135], v[60:63], v[32:39], v5
    s_setprio 0
    ds_read_b128 v[44:47], v152 offset:7168
    v_exp_f32 v10, v10
    v_exp_f32 v11, v11
    v_exp_f32 v12, v12
    v_mfma_f32_32x32x16_bf16 v[24:39], v[40:43], v[68:71], v[88:103]
    ds_read_b128 v[56:59], v154 offset:7168
    v_exp_f32 v13, v13
    v_exp_f32 v14, v14
    v_exp_f32 v15, v15
    v_exp_f32 v16, v16
    v_exp_f32 v17, v17
    v_smfmac_f32_32x32x32_bf16 v[104:119], v[48:51], v[8:15], v5
    ds_read_b128 v[60:63], v154 offset:7680
    v_exp_f32 v18, v18
    v_exp_f32 v19, v19
    v_exp_f32 v20, v20
    v_exp_f32 v21, v21
    v_exp_f32 v22, v22
    v_exp_f32 v23, v23
    v_exp_f32 v24, v24
    v_exp_f32 v25, v25
    v_smfmac_f32_32x32x32_bf16 v[104:119], v[52:55], v[16:23], v5
    v_exp_f32 v26, v26
    v_exp_f32 v27, v27
    v_exp_f32 v28, v28
    s_waitcnt lgkmcnt(0)
    v_mfma_f32_32x32x16_bf16 v[8:23], v[44:47], v[64:67], v[72:87]
    v_exp_f32 v29, v29
    v_exp_f32 v30, v30
    v_exp_f32 v31, v31
    v_exp_f32 v32, v32
    v_exp_f32 v33, v33
    v_smfmac_f32_32x32x32_bf16 v[120:135], v[48:51], v[24:31], v5
    v_exp_f32 v34, v34
    v_exp_f32 v35, v35
    v_exp_f32 v36, v36
    v_exp_f32 v37, v37
    v_exp_f32 v38, v38
    v_exp_f32 v39, v39
    v_exp_f32 v8, v8
    v_exp_f32 v9, v9
    v_smfmac_f32_32x32x32_bf16 v[120:135], v[52:55], v[32:39], v5
    s_waitcnt vmcnt(0)
    s_barrier
    s_setprio 1
    ds_read_b128 v[40:43], v152 offset:32768
    v_exp_f32 v10, v10
    v_exp_f32 v11, v11
    v_exp_f32 v12, v12
    v_mfma_f32_32x32x16_bf16 v[24:39], v[44:47], v[68:71], v[88:103]
    ds_read_b128 v[48:51], v155 offset:0
    v_exp_f32 v13, v13
    v_exp_f32 v14, v14
    v_exp_f32 v15, v15
    v_exp_f32 v16, v16
    v_exp_f32 v17, v17
    v_smfmac_f32_32x32x32_bf16 v[104:119], v[56:59], v[8:15], v5
    ds_read_b128 v[52:55], v155 offset:512
    v_exp_f32 v18, v18
    v_exp_f32 v19, v19
    v_exp_f32 v20, v20
    v_exp_f32 v21, v21
    v_exp_f32 v22, v22
    v_exp_f32 v23, v23
    v_exp_f32 v24, v24
    v_exp_f32 v25, v25
    v_smfmac_f32_32x32x32_bf16 v[104:119], v[60:63], v[16:23], v5
    s_add_u32 s52, s54, s56
    s_add_u32 s53, s52, 65536
    v_exp_f32 v26, v26
    v_exp_f32 v27, v27
    v_exp_f32 v28, v28
    s_waitcnt lgkmcnt(0)
    v_mfma_f32_32x32x16_bf16 v[8:23], v[40:43], v[64:67], v[72:87]
    s_add_u32 s48, s52, 4194304
    v_exp_f32 v29, v29
    v_exp_f32 v30, v30
    v_exp_f32 v31, v31
    v_exp_f32 v32, v32
    v_exp_f32 v33, v33
    v_smfmac_f32_32x32x32_bf16 v[120:135], v[56:59], v[24:31], v5
    s_add_u32 s49, s52, 4259840
    s_add_u32 s43, s56, 0x2000
    v_exp_f32 v34, v34
    v_exp_f32 v35, v35
    v_exp_f32 v36, v36
    v_exp_f32 v37, v37
    v_exp_f32 v38, v38
    v_exp_f32 v39, v39
    v_exp_f32 v8, v8
    v_exp_f32 v9, v9
    v_smfmac_f32_32x32x32_bf16 v[120:135], v[60:63], v[32:39], v5
    ds_read_b128 v[44:47], v152 offset:33792
    v_exp_f32 v10, v10
    v_exp_f32 v11, v11
    v_exp_f32 v12, v12
    v_mfma_f32_32x32x16_bf16 v[24:39], v[40:43], v[68:71], v[88:103]
    ds_read_b128 v[56:59], v155 offset:1024
    v_exp_f32 v13, v13
    v_exp_f32 v14, v14
    v_exp_f32 v15, v15
    v_exp_f32 v16, v16
    v_exp_f32 v17, v17
    v_smfmac_f32_32x32x32_bf16 v[104:119], v[48:51], v[8:15], v5
    ds_read_b128 v[60:63], v155 offset:1536
    v_exp_f32 v18, v18
    v_exp_f32 v19, v19
    v_exp_f32 v20, v20
    v_exp_f32 v21, v21
    v_exp_f32 v22, v22
    v_exp_f32 v23, v23
    v_exp_f32 v24, v24
    v_exp_f32 v25, v25
    v_smfmac_f32_32x32x32_bf16 v[104:119], v[52:55], v[16:23], v5
    s_and_b32 s43, s43, 0x6000
    s_and_b32 s56, s56, 0x8000
    v_exp_f32 v26, v26
    v_exp_f32 v27, v27
    v_exp_f32 v28, v28
    s_waitcnt lgkmcnt(0)
    v_mfma_f32_32x32x16_bf16 v[8:23], v[44:47], v[64:67], v[72:87]
    s_or_b32 s56, s56, s43
    v_exp_f32 v29, v29
    v_exp_f32 v30, v30
    v_exp_f32 v31, v31
    v_exp_f32 v32, v32
    v_exp_f32 v33, v33
    v_smfmac_f32_32x32x32_bf16 v[120:135], v[48:51], v[24:31], v5
    s_add_u32 m0, s57, 65536
    v_exp_f32 v34, v34
    v_exp_f32 v35, v35
    v_exp_f32 v36, v36
    v_exp_f32 v37, v37
    v_exp_f32 v38, v38
    v_exp_f32 v39, v39
    v_exp_f32 v8, v8
    v_exp_f32 v9, v9
    v_smfmac_f32_32x32x32_bf16 v[120:135], v[52:55], v[32:39], v5
    ds_read_b128 v[40:43], v152 offset:34816
    v_exp_f32 v10, v10
    v_exp_f32 v11, v11
    v_exp_f32 v12, v12
    v_mfma_f32_32x32x16_bf16 v[24:39], v[44:47], v[68:71], v[88:103]
    ds_read_b128 v[48:51], v155 offset:2048
    v_exp_f32 v13, v13
    v_exp_f32 v14, v14
    v_exp_f32 v15, v15
    v_exp_f32 v16, v16
    v_exp_f32 v17, v17
    v_smfmac_f32_32x32x32_bf16 v[104:119], v[56:59], v[8:15], v5
    ds_read_b128 v[52:55], v155 offset:2560
    v_exp_f32 v18, v18
    v_exp_f32 v19, v19
    v_exp_f32 v20, v20
    v_exp_f32 v21, v21
    v_exp_f32 v22, v22
    v_exp_f32 v23, v23
    v_exp_f32 v24, v24
    v_exp_f32 v25, v25
    v_smfmac_f32_32x32x32_bf16 v[104:119], v[60:63], v[16:23], v5
    buffer_load_dwordx4 v2, s[8:11], s52 offen sc1 lds
    v_exp_f32 v26, v26
    v_exp_f32 v27, v27
    v_exp_f32 v28, v28
    s_waitcnt lgkmcnt(0)
    v_mfma_f32_32x32x16_bf16 v[8:23], v[40:43], v[64:67], v[72:87]
    s_add_u32 m0, s57, 73728
    v_exp_f32 v29, v29
    v_exp_f32 v30, v30
    v_exp_f32 v31, v31
    v_exp_f32 v32, v32
    v_exp_f32 v33, v33
    v_smfmac_f32_32x32x32_bf16 v[120:135], v[56:59], v[24:31], v5
    buffer_load_dwordx4 v2, s[8:11], s53 offen sc1 lds
    v_exp_f32 v34, v34
    v_exp_f32 v35, v35
    v_exp_f32 v36, v36
    v_exp_f32 v37, v37
    v_exp_f32 v38, v38
    v_exp_f32 v39, v39
    v_exp_f32 v8, v8
    v_exp_f32 v9, v9
    v_smfmac_f32_32x32x32_bf16 v[120:135], v[60:63], v[32:39], v5
    ds_read_b128 v[44:47], v152 offset:35840
    v_exp_f32 v10, v10
    v_exp_f32 v11, v11
    v_exp_f32 v12, v12
    v_mfma_f32_32x32x16_bf16 v[24:39], v[40:43], v[68:71], v[88:103]
    ds_read_b128 v[56:59], v155 offset:3072
    v_exp_f32 v13, v13
    v_exp_f32 v14, v14
    v_exp_f32 v15, v15
    v_exp_f32 v16, v16
    v_exp_f32 v17, v17
    v_smfmac_f32_32x32x32_bf16 v[104:119], v[48:51], v[8:15], v5
    ds_read_b128 v[60:63], v155 offset:3584
    v_exp_f32 v18, v18
    v_exp_f32 v19, v19
    v_exp_f32 v20, v20
    v_exp_f32 v21, v21
    v_exp_f32 v22, v22
    v_exp_f32 v23, v23
    v_exp_f32 v24, v24
    v_exp_f32 v25, v25
    v_smfmac_f32_32x32x32_bf16 v[104:119], v[52:55], v[16:23], v5
    s_add_u32 m0, s57, 81920
    v_exp_f32 v26, v26
    v_exp_f32 v27, v27
    v_exp_f32 v28, v28
    s_waitcnt lgkmcnt(0)
    v_mfma_f32_32x32x16_bf16 v[8:23], v[44:47], v[64:67], v[72:87]
    buffer_load_dwordx4 v2, s[8:11], s48 offen sc1 lds
    v_exp_f32 v29, v29
    v_exp_f32 v30, v30
    v_exp_f32 v31, v31
    v_exp_f32 v32, v32
    v_exp_f32 v33, v33
    v_smfmac_f32_32x32x32_bf16 v[120:135], v[48:51], v[24:31], v5
    s_add_u32 m0, s57, 90112
    v_exp_f32 v34, v34
    v_exp_f32 v35, v35
    v_exp_f32 v36, v36
    v_exp_f32 v37, v37
    v_exp_f32 v38, v38
    v_exp_f32 v39, v39
    v_exp_f32 v8, v8
    v_exp_f32 v9, v9
    v_smfmac_f32_32x32x32_bf16 v[120:135], v[52:55], v[32:39], v5
    ds_read_b128 v[40:43], v152 offset:36864
    v_exp_f32 v10, v10
    v_exp_f32 v11, v11
    v_exp_f32 v12, v12
    v_mfma_f32_32x32x16_bf16 v[24:39], v[44:47], v[68:71], v[88:103]
    ds_read_b128 v[48:51], v155 offset:4096
    v_exp_f32 v13, v13
    v_exp_f32 v14, v14
    v_exp_f32 v15, v15
    v_exp_f32 v16, v16
    v_exp_f32 v17, v17
    v_smfmac_f32_32x32x32_bf16 v[104:119], v[56:59], v[8:15], v5
    ds_read_b128 v[52:55], v155 offset:4608
    v_exp_f32 v18, v18
    v_exp_f32 v19, v19
    v_exp_f32 v20, v20
    v_exp_f32 v21, v21
    v_exp_f32 v22, v22
    v_exp_f32 v23, v23
    v_exp_f32 v24, v24
    v_exp_f32 v25, v25
    v_smfmac_f32_32x32x32_bf16 v[104:119], v[60:63], v[16:23], v5
    buffer_load_dwordx4 v2, s[8:11], s49 offen sc1 lds
    v_exp_f32 v26, v26
    v_exp_f32 v27, v27
    v_exp_f32 v28, v28
    s_waitcnt lgkmcnt(0)
    v_mfma_f32_32x32x16_bf16 v[8:23], v[40:43], v[64:67], v[72:87]
    buffer_load_dword v138, v149, s[8:11], s58 offen sc1
    v_exp_f32 v29, v29
    v_exp_f32 v30, v30
    v_exp_f32 v31, v31
    v_exp_f32 v32, v32
    v_exp_f32 v33, v33
    v_smfmac_f32_32x32x32_bf16 v[120:135], v[56:59], v[24:31], v5
    v_exp_f32 v34, v34
    v_exp_f32 v35, v35
    v_exp_f32 v36, v36
    v_exp_f32 v37, v37
    v_exp_f32 v38, v38
    v_exp_f32 v39, v39
    s_waitcnt vmcnt(0)
    v_cmp_ne_u32 vcc, s7, v138
    s_cbranch_vccnz L_far
L_far_ok:
    v_exp_f32 v8, v8
    v_exp_f32 v9, v9
    v_smfmac_f32_32x32x32_bf16 v[120:135], v[60:63], v[32:39], v5
    ds_read_b128 v[44:47], v152 offset:37888
    v_exp_f32 v10, v10
    v_exp_f32 v11, v11
    v_exp_f32 v12, v12
    v_mfma_f32_32x32x16_bf16 v[24:39], v[40:43], v[68:71], v[88:103]
    ds_read_b128 v[56:59], v155 offset:5120
    v_exp_f32 v13, v13
    v_exp_f32 v14, v14
    v_exp_f32 v15, v15
    v_exp_f32 v16, v16
    v_exp_f32 v17, v17
    v_smfmac_f32_32x32x32_bf16 v[104:119], v[48:51], v[8:15], v5
    ds_read_b128 v[60:63], v155 offset:5632
    v_exp_f32 v18, v18
    v_exp_f32 v19, v19
    v_exp_f32 v20, v20
    v_exp_f32 v21, v21
    v_exp_f32 v22, v22
    v_exp_f32 v23, v23
    v_exp_f32 v24, v24
    v_exp_f32 v25, v25
    v_smfmac_f32_32x32x32_bf16 v[104:119], v[52:55], v[16:23], v5
    s_add_u32 s52, s54, s56
    s_add_u32 s53, s52, 65536
    v_exp_f32 v26, v26
    v_exp_f32 v27, v27
    v_exp_f32 v28, v28
    s_waitcnt lgkmcnt(0)
    v_mfma_f32_32x32x16_bf16 v[8:23], v[44:47], v[64:67], v[72:87]
    s_add_u32 s48, s52, 4194304
    v_exp_f32 v29, v29
    v_exp_f32 v30, v30
    v_exp_f32 v31, v31
    v_exp_f32 v32, v32
    v_exp_f32 v33, v33
    v_smfmac_f32_32x32x32_bf16 v[120:135], v[48:51], v[24:31], v5
    s_add_u32 s49, s52, 4259840
    s_add_u32 s43, s56, 0x2000
    v_exp_f32 v34, v34
    v_exp_f32 v35, v35
    v_exp_f32 v36, v36
    v_exp_f32 v37, v37
    v_exp_f32 v38, v38
    v_exp_f32 v39, v39
    v_exp_f32 v8, v8
    v_exp_f32 v9, v9
    v_smfmac_f32_32x32x32_bf16 v[120:135], v[52:55], v[32:39], v5
    ds_read_b128 v[40:43], v152 offset:38912
    v_exp_f32 v10, v10
    v_exp_f32 v11, v11
    v_exp_f32 v12, v12
    v_mfma_f32_32x32x16_bf16 v[24:39], v[44:47], v[68:71], v[88:103]
    ds_read_b128 v[48:51], v155 offset:6144
    v_exp_f32 v13, v13
    v_exp_f32 v14, v14
    v_exp_f32 v15, v15
    v_exp_f32 v16, v16
    v_exp_f32 v17, v17
    v_smfmac_f32_32x32x32_bf16 v[104:119], v[56:59], v[8:15], v5
    ds_read_b128 v[52:55], v155 offset:6656
    v_exp_f32 v18, v18
    v_exp_f32 v19, v19
    v_exp_f32 v20, v20
    v_exp_f32 v21, v21
    v_exp_f32 v22, v22
    v_exp_f32 v23, v23
    v_exp_f32 v24, v24
    v_exp_f32 v25, v25
    v_smfmac_f32_32x32x32_bf16 v[104:119], v[60:63], v[16:23], v5
    s_and_b32 s43, s43, 0x6000
    s_and_b32 s56, s56, 0x8000
    v_exp_f32 v26, v26
    v_exp_f32 v27, v27
    v_exp_f32 v28, v28
    s_waitcnt lgkmcnt(0)
    v_mfma_f32_32x32x16_bf16 v[8:23], v[40:43], v[64:67], v[72:87]
    s_or_b32 s56, s56, s43
    v_exp_f32 v29, v29
    v_exp_f32 v30, v30
    v_exp_f32 v31, v31
    v_exp_f32 v32, v32
    v_exp_f32 v33, v33
    v_smfmac_f32_32x32x32_bf16 v[120:135], v[56:59], v[24:31], v5
    s_xor_b32 s56, s56, 0x8000
    s_add_u32 m0, s57, 98304
    v_exp_f32 v34, v34
    v_exp_f32 v35, v35
    v_exp_f32 v36, v36
    v_exp_f32 v37, v37
    v_exp_f32 v38, v38
    v_exp_f32 v39, v39
    v_exp_f32 v8, v8
    v_exp_f32 v9, v9
    v_smfmac_f32_32x32x32_bf16 v[120:135], v[60:63], v[32:39], v5
    s_setprio 0
    ds_read_b128 v[44:47], v152 offset:39936
    v_exp_f32 v10, v10
    v_exp_f32 v11, v11
    v_exp_f32 v12, v12
    v_mfma_f32_32x32x16_bf16 v[24:39], v[40:43], v[68:71], v[88:103]
    ds_read_b128 v[56:59], v155 offset:7168
    v_exp_f32 v13, v13
    v_exp_f32 v14, v14
    v_exp_f32 v15, v15
    v_exp_f32 v16, v16
    v_exp_f32 v17, v17
    v_smfmac_f32_32x32x32_bf16 v[104:119], v[48:51], v[8:15], v5
    ds_read_b128 v[60:63], v155 offset:7680
    v_exp_f32 v18, v18
    v_exp_f32 v19, v19
    v_exp_f32 v20, v20
    v_exp_f32 v21, v21
    v_exp_f32 v22, v22
    v_exp_f32 v23, v23
    v_exp_f32 v24, v24
    v_exp_f32 v25, v25
    v_smfmac_f32_32x32x32_bf16 v[104:119], v[52:55], v[16:23], v5
    buffer_load_dwordx4 v2, s[8:11], s52 offen sc1 lds
    v_exp_f32 v26, v26
    v_exp_f32 v27, v27
    v_exp_f32 v28, v28
    s_waitcnt lgkmcnt(0)
    v_mfma_f32_32x32x16_bf16 v[8:23], v[44:47], v[64:67], v[72:87]
    s_add_u32 m0, s57, 106496
    v_exp_f32 v29, v29
    v_exp_f32 v30, v30
    v_exp_f32 v31, v31
    v_exp_f32 v32, v32
    v_exp_f32 v33, v33
    v_smfmac_f32_32x32x32_bf16 v[120:135], v[48:51], v[24:31], v5
    buffer_load_dwordx4 v2, s[8:11], s53 offen sc1 lds
    v_exp_f32 v34, v34
    v_exp_f32 v35, v35
    v_exp_f32 v36, v36
    v_exp_f32 v37, v37
    v_exp_f32 v38, v38
    v_exp_f32 v39, v39
    v_exp_f32 v8, v8
    v_exp_f32 v9, v9
    v_smfmac_f32_32x32x32_bf16 v[120:135], v[52:55], v[32:39], v5
    s_waitcnt vmcnt(3)
    s_barrier
    s_setprio 1
    ds_read_b128 v[40:43], v153 offset:0
    v_exp_f32 v10, v10
    v_exp_f32 v11, v11
    v_exp_f32 v12, v12
    v_mfma_f32_32x32x16_bf16 v[24:39], v[44:47], v[68:71], v[88:103]
    ds_read_b128 v[48:51], v156 offset:0
    v_exp_f32 v13, v13
    v_exp_f32 v14, v14
    v_exp_f32 v15, v15
    v_exp_f32 v16, v16
    v_exp_f32 v17, v17
    v_smfmac_f32_32x32x32_bf16 v[104:119], v[56:59], v[8:15], v5
    ds_read_b128 v[52:55], v156 offset:512
    v_exp_f32 v18, v18
    v_exp_f32 v19, v19
    v_exp_f32 v20, v20
    v_exp_f32 v21, v21
    v_exp_f32 v22, v22
    v_exp_f32 v23, v23
    v_exp_f32 v24, v24
    v_exp_f32 v25, v25
    v_smfmac_f32_32x32x32_bf16 v[104:119], v[60:63], v[16:23], v5
    s_add_u32 m0, s57, 114688
    v_exp_f32 v26, v26
    v_exp_f32 v27, v27
    v_exp_f32 v28, v28
    s_waitcnt lgkmcnt(0)
    v_mfma_f32_32x32x16_bf16 v[8:23], v[40:43], v[64:67], v[72:87]
    buffer_load_dwordx4 v2, s[8:11], s48 offen sc1 lds
    v_exp_f32 v29, v29
    v_exp_f32 v30, v30
    v_exp_f32 v31, v31
    v_exp_f32 v32, v32
    v_exp_f32 v33, v33
    v_smfmac_f32_32x32x32_bf16 v[120:135], v[56:59], v[24:31], v5
    s_add_u32 m0, s57, 122880
    v_exp_f32 v34, v34
    v_exp_f32 v35, v35
    v_exp_f32 v36, v36
    v_exp_f32 v37, v37
    v_exp_f32 v38, v38
    v_exp_f32 v39, v39
    v_exp_f32 v8, v8
    v_exp_f32 v9, v9
    v_smfmac_f32_32x32x32_bf16 v[120:135], v[60:63], v[32:39], v5
    ds_read_b128 v[44:47], v153 offset:1024
    v_exp_f32 v10, v10
    v_exp_f32 v11, v11
    v_exp_f32 v12, v12
    v_mfma_f32_32x32x16_bf16 v[24:39], v[40:43], v[68:71], v[88:103]
    ds_read_b128 v[56:59], v156 offset:1024
    v_exp_f32 v13, v13
    v_exp_f32 v14, v14
    v_exp_f32 v15, v15
    v_exp_f32 v16, v16
    v_exp_f32 v17, v17
    v_smfmac_f32_32x32x32_bf16 v[104:119], v[48:51], v[8:15], v5
    ds_read_b128 v[60:63], v156 offset:1536
    v_exp_f32 v18, v18
    v_exp_f32 v19, v19
    v_exp_f32 v20, v20
    v_exp_f32 v21, v21
    v_exp_f32 v22, v22
    v_exp_f32 v23, v23
    v_exp_f32 v24, v24
    v_exp_f32 v25, v25
    v_smfmac_f32_32x32x32_bf16 v[104:119], v[52:55], v[16:23], v5
    buffer_load_dwordx4 v2, s[8:11], s49 offen sc1 lds
    v_exp_f32 v26, v26
    v_exp_f32 v27, v27
    v_exp_f32 v28, v28
    s_waitcnt lgkmcnt(0)
    v_mfma_f32_32x32x16_bf16 v[8:23], v[44:47], v[64:67], v[72:87]
    s_add_u32 s52, s54, s56
    v_exp_f32 v29, v29
    v_exp_f32 v30, v30
    v_exp_f32 v31, v31
    v_exp_f32 v32, v32
    v_exp_f32 v33, v33
    v_smfmac_f32_32x32x32_bf16 v[120:135], v[48:51], v[24:31], v5
    s_add_u32 s53, s52, 65536
    s_add_u32 s48, s52, 4194304
    v_exp_f32 v34, v34
    v_exp_f32 v35, v35
    v_exp_f32 v36, v36
    v_exp_f32 v37, v37
    v_exp_f32 v38, v38
    v_exp_f32 v39, v39
    v_exp_f32 v8, v8
    v_exp_f32 v9, v9
    v_smfmac_f32_32x32x32_bf16 v[120:135], v[52:55], v[32:39], v5
    ds_read_b128 v[40:43], v153 offset:2048
    v_exp_f32 v10, v10
    v_exp_f32 v11, v11
    v_exp_f32 v12, v12
    v_mfma_f32_32x32x16_bf16 v[24:39], v[44:47], v[68:71], v[88:103]
    ds_read_b128 v[48:51], v156 offset:2048
    v_exp_f32 v13, v13
    v_exp_f32 v14, v14
    v_exp_f32 v15, v15
    v_exp_f32 v16, v16
    v_exp_f32 v17, v17
    v_smfmac_f32_32x32x32_bf16 v[104:119], v[56:59], v[8:15], v5
    ds_read_b128 v[52:55], v156 offset:2560
    v_exp_f32 v18, v18
    v_exp_f32 v19, v19
    v_exp_f32 v20, v20
    v_exp_f32 v21, v21
    v_exp_f32 v22, v22
    v_exp_f32 v23, v23
    v_exp_f32 v24, v24
    v_exp_f32 v25, v25
    v_smfmac_f32_32x32x32_bf16 v[104:119], v[60:63], v[16:23], v5
    s_add_u32 s49, s52, 4259840
    s_add_u32 s43, s56, 0x2000
    v_exp_f32 v26, v26
    v_exp_f32 v27, v27
    v_exp_f32 v28, v28
    s_waitcnt lgkmcnt(0)
    v_mfma_f32_32x32x16_bf16 v[8:23], v[40:43], v[64:67], v[72:87]
    s_and_b32 s43, s43, 0x6000
    v_exp_f32 v29, v29
    v_exp_f32 v30, v30
    v_exp_f32 v31, v31
    v_exp_f32 v32, v32
    v_exp_f32 v33, v33
    v_smfmac_f32_32x32x32_bf16 v[120:135], v[56:59], v[24:31], v5
    s_and_b32 s56, s56, 0x8000
    s_or_b32 s56, s56, s43
    v_exp_f32 v34, v34
    v_exp_f32 v35, v35
    v_exp_f32 v36, v36
    v_exp_f32 v37, v37
    v_exp_f32 v38, v38
    v_exp_f32 v39, v39
    v_exp_f32 v8, v8
    v_exp_f32 v9, v9
    v_smfmac_f32_32x32x32_bf16 v[120:135], v[60:63], v[32:39], v5
    ds_read_b128 v[44:47], v153 offset:3072
    v_exp_f32 v10, v10
    v_exp_f32 v11, v11
    v_exp_f32 v12, v12
    v_mfma_f32_32x32x16_bf16 v[24:39], v[40:43], v[68:71], v[88:103]
    ds_read_b128 v[56:59], v156 offset:3072
    v_exp_f32 v13, v13
    v_exp_f32 v14, v14
    v_exp_f32 v15, v15
    v_exp_f32 v16, v16
    v_exp_f32 v17, v17
    v_smfmac_f32_32x32x32_bf16 v[104:119], v[48:51], v[8:15], v5
    ds_read_b128 v[60:63], v156 offset:3584
    v_exp_f32 v18, v18
    v_exp_f32 v19, v19
    v_exp_f32 v20, v20
    v_exp_f32 v21, v21
    v_exp_f32 v22, v22
    v_exp_f32 v23, v23
    v_exp_f32 v24, v24
    v_exp_f32 v25, v25
    v_smfmac_f32_32x32x32_bf16 v[104:119], v[52:55], v[16:23], v5
    s_add_u32 m0, s57, 0
    v_exp_f32 v26, v26
    v_exp_f32 v27, v27
    v_exp_f32 v28, v28
    s_waitcnt lgkmcnt(0)
    v_mfma_f32_32x32x16_bf16 v[8:23], v[44:47], v[64:67], v[72:87]
    buffer_load_dwordx4 v2, s[8:11], s52 offen sc1 lds
    v_exp_f32 v29, v29
    v_exp_f32 v30, v30
    v_exp_f32 v31, v31
    v_exp_f32 v32, v32
    v_exp_f32 v33, v33
    v_smfmac_f32_32x32x32_bf16 v[120:135], v[48:51], v[24:31], v5
    s_add_u32 m0, s57, 8192
    v_exp_f32 v34, v34
    v_exp_f32 v35, v35
    v_exp_f32 v36, v36
    v_exp_f32 v37, v37
    v_exp_f32 v38, v38
    v_exp_f32 v39, v39
    v_exp_f32 v8, v8
    v_exp_f32 v9, v9
    v_smfmac_f32_32x32x32_bf16 v[120:135], v[52:55], v[32:39], v5
    ds_read_b128 v[40:43], v153 offset:4096
    v_exp_f32 v10, v10
    v_exp_f32 v11, v11
    v_exp_f32 v12, v12
    v_mfma_f32_32x32x16_bf16 v[24:39], v[44:47], v[68:71], v[88:103]
    ds_read_b128 v[48:51], v156 offset:4096
    v_exp_f32 v13, v13
    v_exp_f32 v14, v14
    v_exp_f32 v15, v15
    v_exp_f32 v16, v16
    v_exp_f32 v17, v17
    v_smfmac_f32_32x32x32_bf16 v[104:119], v[56:59], v[8:15], v5
    ds_read_b128 v[52:55], v156 offset:4608
    v_exp_f32 v18, v18
    v_exp_f32 v19, v19
    v_exp_f32 v20, v20
    v_exp_f32 v21, v21
    v_exp_f32 v22, v22
    v_exp_f32 v23, v23
    v_exp_f32 v24, v24
    v_exp_f32 v25, v25
    v_smfmac_f32_32x32x32_bf16 v[104:119], v[60:63], v[16:23], v5
    buffer_load_dwordx4 v2, s[8:11], s53 offen sc1 lds
    v_exp_f32 v26, v26
    v_exp_f32 v27, v27
    v_exp_f32 v28, v28
    s_waitcnt lgkmcnt(0)
    v_mfma_f32_32x32x16_bf16 v[8:23], v[40:43], v[64:67], v[72:87]
    s_add_u32 m0, s57, 16384
    v_exp_f32 v29, v29
    v_exp_f32 v30, v30
    v_exp_f32 v31, v31
    v_exp_f32 v32, v32
    v_exp_f32 v33, v33
    v_smfmac_f32_32x32x32_bf16 v[120:135], v[56:59], v[24:31], v5
    buffer_load_dwordx4 v2, s[8:11], s48 offen sc1 lds
    v_exp_f32 v34, v34
    v_exp_f32 v35, v35
    v_exp_f32 v36, v36
    v_exp_f32 v37, v37
    v_exp_f32 v38, v38
    v_exp_f32 v39, v39
    v_exp_f32 v8, v8
    v_exp_f32 v9, v9
    v_smfmac_f32_32x32x32_bf16 v[120:135], v[60:63], v[32:39], v5
    ds_read_b128 v[44:47], v153 offset:5120
    v_exp_f32 v10, v10
    v_exp_f32 v11, v11
    v_exp_f32 v12, v12
    v_mfma_f32_32x32x16_bf16 v[24:39], v[40:43], v[68:71], v[88:103]
    ds_read_b128 v[56:59], v156 offset:5120
    v_exp_f32 v13, v13
    v_exp_f32 v14, v14
    v_exp_f32 v15, v15
    v_exp_f32 v16, v16
    v_exp_f32 v17, v17
    v_smfmac_f32_32x32x32_bf16 v[104:119], v[48:51], v[8:15], v5
    ds_read_b128 v[60:63], v156 offset:5632
    v_exp_f32 v18, v18
    v_exp_f32 v19, v19
    v_exp_f32 v20, v20
    v_exp_f32 v21, v21
    v_exp_f32 v22, v22
    v_exp_f32 v23, v23
    v_exp_f32 v24, v24
    v_exp_f32 v25, v25
    v_smfmac_f32_32x32x32_bf16 v[104:119], v[52:55], v[16:23], v5
    s_add_u32 m0, s57, 24576
    v_exp_f32 v26, v26
    v_exp_f32 v27, v27
    v_exp_f32 v28, v28
    s_waitcnt lgkmcnt(0)
    v_mfma_f32_32x32x16_bf16 v[8:23], v[44:47], v[64:67], v[72:87]
    buffer_load_dwordx4 v2, s[8:11], s49 offen sc1 lds
    v_exp_f32 v29, v29
    v_exp_f32 v30, v30
    v_exp_f32 v31, v31
    v_exp_f32 v32, v32
    v_exp_f32 v33, v33
    v_smfmac_f32_32x32x32_bf16 v[120:135], v[48:51], v[24:31], v5
    v_exp_f32 v34, v34
    v_exp_f32 v35, v35
    v_exp_f32 v36, v36
    v_exp_f32 v37, v37
    v_exp_f32 v38, v38
    v_exp_f32 v39, v39
    v_exp_f32 v8, v8
    v_exp_f32 v9, v9
    v_smfmac_f32_32x32x32_bf16 v[120:135], v[52:55], v[32:39], v5
    ds_read_b128 v[40:43], v153 offset:6144
    v_exp_f32 v10, v10
    v_exp_f32 v11, v11
    v_exp_f32 v12, v12
    v_mfma_f32_32x32x16_bf16 v[24:39], v[44:47], v[68:71], v[88:103]
    ds_read_b128 v[48:51], v156 offset:6144
    v_exp_f32 v13, v13
    v_exp_f32 v14, v14
    v_exp_f32 v15, v15
    v_exp_f32 v16, v16
    v_exp_f32 v17, v17
    v_smfmac_f32_32x32x32_bf16 v[104:119], v[56:59], v[8:15], v5
    ds_read_b128 v[52:55], v156 offset:6656
    v_exp_f32 v18, v18
    v_exp_f32 v19, v19
    v_exp_f32 v20, v20
    v_exp_f32 v21, v21
    v_exp_f32 v22, v22
    v_exp_f32 v23, v23
    v_exp_f32 v24, v24
    v_exp_f32 v25, v25
    v_smfmac_f32_32x32x32_bf16 v[104:119], v[60:63], v[16:23], v5
    v_exp_f32 v26, v26
    v_exp_f32 v27, v27
    v_exp_f32 v28, v28
    s_waitcnt lgkmcnt(0)
    v_mfma_f32_32x32x16_bf16 v[8:23], v[40:43], v[64:67], v[72:87]
    v_exp_f32 v29, v29
    v_exp_f32 v30, v30
    v_exp_f32 v31, v31
    v_exp_f32 v32, v32
    v_exp_f32 v33, v33
    v_smfmac_f32_32x32x32_bf16 v[120:135], v[56:59], v[24:31], v5
    v_exp_f32 v34, v34
    v_exp_f32 v35, v35
    v_exp_f32 v36, v36
    v_exp_f32 v37, v37
    v_exp_f32 v38, v38
    v_exp_f32 v39, v39
    v_exp_f32 v8, v8
    v_exp_f32 v9, v9
    v_smfmac_f32_32x32x32_bf16 v[120:135], v[60:63], v[32:39], v5
    s_setprio 0
    ds_read_b128 v[44:47], v153 offset:7168
    v_exp_f32 v10, v10
    v_exp_f32 v11, v11
    v_exp_f32 v12, v12
    v_mfma_f32_32x32x16_bf16 v[24:39], v[40:43], v[68:71], v[88:103]
    ds_read_b128 v[56:59], v156 offset:7168
    v_exp_f32 v13, v13
    v_exp_f32 v14, v14
    v_exp_f32 v15, v15
    v_exp_f32 v16, v16
    v_exp_f32 v17, v17
    v_smfmac_f32_32x32x32_bf16 v[104:119], v[48:51], v[8:15], v5
    ds_read_b128 v[60:63], v156 offset:7680
    v_exp_f32 v18, v18
    v_exp_f32 v19, v19
    v_exp_f32 v20, v20
    v_exp_f32 v21, v21
    v_exp_f32 v22, v22
    v_exp_f32 v23, v23
    v_exp_f32 v24, v24
    v_exp_f32 v25, v25
    v_smfmac_f32_32x32x32_bf16 v[104:119], v[52:55], v[16:23], v5
    v_exp_f32 v26, v26
    v_exp_f32 v27, v27
    v_exp_f32 v28, v28
    s_waitcnt lgkmcnt(0)
    v_mfma_f32_32x32x16_bf16 v[8:23], v[44:47], v[64:67], v[72:87]
    v_exp_f32 v29, v29
    v_exp_f32 v30, v30
    v_exp_f32 v31, v31
    v_exp_f32 v32, v32
    v_exp_f32 v33, v33
    v_smfmac_f32_32x32x32_bf16 v[120:135], v[48:51], v[24:31], v5
    v_exp_f32 v34, v34
    v_exp_f32 v35, v35
    v_exp_f32 v36, v36
    v_exp_f32 v37, v37
    v_exp_f32 v38, v38
    v_exp_f32 v39, v39
    v_exp_f32 v8, v8
    v_exp_f32 v9, v9
    v_smfmac_f32_32x32x32_bf16 v[120:135], v[52:55], v[32:39], v5
    s_waitcnt vmcnt(4)
    s_barrier
    s_setprio 1
    ds_read_b128 v[40:43], v153 offset:32768
    v_exp_f32 v10, v10
    v_exp_f32 v11, v11
    v_exp_f32 v12, v12
    v_mfma_f32_32x32x16_bf16 v[24:39], v[44:47], v[68:71], v[88:103]
    ds_read_b128 v[48:51], v157 offset:0
    v_exp_f32 v13, v13
    v_exp_f32 v14, v14
    v_exp_f32 v15, v15
    v_exp_f32 v16, v16
    v_exp_f32 v17, v17
    v_smfmac_f32_32x32x32_bf16 v[104:119], v[56:59], v[8:15], v5
    ds_read_b128 v[52:55], v157 offset:512
    v_exp_f32 v18, v18
    v_exp_f32 v19, v19
    v_exp_f32 v20, v20
    v_exp_f32 v21, v21
    v_exp_f32 v22, v22
    v_exp_f32 v23, v23
    v_exp_f32 v24, v24
    v_exp_f32 v25, v25
    v_smfmac_f32_32x32x32_bf16 v[104:119], v[60:63], v[16:23], v5
    v_exp_f32 v26, v26
    v_exp_f32 v27, v27
    v_exp_f32 v28, v28
    s_waitcnt lgkmcnt(0)
    v_mfma_f32_32x32x16_bf16 v[8:23], v[40:43], v[64:67], v[72:87]
    v_exp_f32 v29, v29
    v_exp_f32 v30, v30
    v_exp_f32 v31, v31
    v_exp_f32 v32, v32
    v_exp_f32 v33, v33
    v_smfmac_f32_32x32x32_bf16 v[120:135], v[56:59], v[24:31], v5
    v_exp_f32 v34, v34
    v_exp_f32 v35, v35
    v_exp_f32 v36, v36
    v_exp_f32 v37, v37
    v_exp_f32 v38, v38
    v_exp_f32 v39, v39
    v_exp_f32 v8, v8
    v_exp_f32 v9, v9
    v_smfmac_f32_32x32x32_bf16 v[120:135], v[60:63], v[32:39], v5
    ds_read_b128 v[44:47], v153 offset:33792
    v_exp_f32 v10, v10
    v_exp_f32 v11, v11
    v_exp_f32 v12, v12
    v_mfma_f32_32x32x16_bf16 v[24:39], v[40:43], v[68:71], v[88:103]
    ds_read_b128 v[56:59], v157 offset:1024
    v_exp_f32 v13, v13
    v_exp_f32 v14, v14
    v_exp_f32 v15, v15
    v_exp_f32 v16, v16
    v_exp_f32 v17, v17
    v_smfmac_f32_32x32x32_bf16 v[104:119], v[48:51], v[8:15], v5
    ds_read_b128 v[60:63], v157 offset:1536
    v_exp_f32 v18, v18
    v_exp_f32 v19, v19
    v_exp_f32 v20, v20
    v_exp_f32 v21, v21
    v_exp_f32 v22, v22
    v_exp_f32 v23, v23
    v_exp_f32 v24, v24
    v_exp_f32 v25, v25
    v_smfmac_f32_32x32x32_bf16 v[104:119], v[52:55], v[16:23], v5
    s_add_u32 s52, s54, s56
    s_add_u32 s53, s52, 65536
    v_exp_f32 v26, v26
    v_exp_f32 v27, v27
    v_exp_f32 v28, v28
    s_waitcnt lgkmcnt(0)
    v_mfma_f32_32x32x16_bf16 v[8:23], v[44:47], v[64:67], v[72:87]
    s_add_u32 s48, s52, 4194304
    v_exp_f32 v29, v29
    v_exp_f32 v30, v30
    v_exp_f32 v31, v31
    v_exp_f32 v32, v32
    v_exp_f32 v33, v33
    v_smfmac_f32_32x32x32_bf16 v[120:135], v[48:51], v[24:31], v5
    s_add_u32 s49, s52, 4259840
    s_add_u32 s43, s56, 0x2000
    v_exp_f32 v34, v34
    v_exp_f32 v35, v35
    v_exp_f32 v36, v36
    v_exp_f32 v37, v37
    v_exp_f32 v38, v38
    v_exp_f32 v39, v39
    v_exp_f32 v8, v8
    v_exp_f32 v9, v9
    v_smfmac_f32_32x32x32_bf16 v[120:135], v[52:55], v[32:39], v5
    ds_read_b128 v[40:43], v153 offset:34816
    v_exp_f32 v10, v10
    v_exp_f32 v11, v11
    v_exp_f32 v12, v12
    v_mfma_f32_32x32x16_bf16 v[24:39], v[44:47], v[68:71], v[88:103]
    ds_read_b128 v[48:51], v157 offset:2048
    v_exp_f32 v13, v13
    v_exp_f32 v14, v14
    v_exp_f32 v15, v15
    v_exp_f32 v16, v16
    v_exp_f32 v17, v17
    v_smfmac_f32_32x32x32_bf16 v[104:119], v[56:59], v[8:15], v5
    ds_read_b128 v[52:55], v157 offset:2560
    v_exp_f32 v18, v18
    v_exp_f32 v19, v19
    v_exp_f32 v20, v20
    v_exp_f32 v21, v21
    v_exp_f32 v22, v22
    v_exp_f32 v23, v23
    v_exp_f32 v24, v24
    v_exp_f32 v25, v25
    v_smfmac_f32_32x32x32_bf16 v[104:119], v[60:63], v[16:23], v5
    s_and_b32 s43, s43, 0x6000
    s_and_b32 s56, s56, 0x8000
    v_exp_f32 v26, v26
    v_exp_f32 v27, v27
    v_exp_f32 v28, v28
    s_waitcnt lgkmcnt(0)
    v_mfma_f32_32x32x16_bf16 v[8:23], v[40:43], v[64:67], v[72:87]
    s_or_b32 s56, s56, s43
    v_exp_f32 v29, v29
    v_exp_f32 v30, v30
    v_exp_f32 v31, v31
    v_exp_f32 v32, v32
    v_exp_f32 v33, v33
    v_smfmac_f32_32x32x32_bf16 v[120:135], v[56:59], v[24:31], v5
    s_add_u32 m0, s57, 32768
    v_exp_f32 v34, v34
    v_exp_f32 v35, v35
    v_exp_f32 v36, v36
    v_exp_f32 v37, v37
    v_exp_f32 v38, v38
    v_exp_f32 v39, v39
    v_exp_f32 v8, v8
    v_exp_f32 v9, v9
    v_smfmac_f32_32x32x32_bf16 v[120:135], v[60:63], v[32:39], v5
    ds_read_b128 v[44:47], v153 offset:35840
    v_exp_f32 v10, v10
    v_exp_f32 v11, v11
    v_exp_f32 v12, v12
    v_mfma_f32_32x32x16_bf16 v[24:39], v[40:43], v[68:71], v[88:103]
    ds_read_b128 v[56:59], v157 offset:3072
    v_exp_f32 v13, v13
    v_exp_f32 v14, v14
    v_exp_f32 v15, v15
    v_exp_f32 v16, v16
    v_exp_f32 v17, v17
    v_smfmac_f32_32x32x32_bf16 v[104:119], v[48:51], v[8:15], v5
    ds_read_b128 v[60:63], v157 offset:3584
    v_exp_f32 v18, v18
    v_exp_f32 v19, v19
    v_exp_f32 v20, v20
    v_exp_f32 v21, v21
    v_exp_f32 v22, v22
    v_exp_f32 v23, v23
    v_exp_f32 v24, v24
    v_exp_f32 v25, v25
    v_smfmac_f32_32x32x32_bf16 v[104:119], v[52:55], v[16:23], v5
    buffer_load_dwordx4 v2, s[8:11], s52 offen sc1 lds
    v_exp_f32 v26, v26
    v_exp_f32 v27, v27
    v_exp_f32 v28, v28
    s_waitcnt lgkmcnt(0)
    v_mfma_f32_32x32x16_bf16 v[8:23], v[44:47], v[64:67], v[72:87]
    s_add_u32 m0, s57, 40960
    v_exp_f32 v29, v29
    v_exp_f32 v30, v30
    v_exp_f32 v31, v31
    v_exp_f32 v32, v32
    v_exp_f32 v33, v33
    v_smfmac_f32_32x32x32_bf16 v[120:135], v[48:51], v[24:31], v5
    buffer_load_dwordx4 v2, s[8:11], s53 offen sc1 lds
    v_exp_f32 v34, v34
    v_exp_f32 v35, v35
    v_exp_f32 v36, v36
    v_exp_f32 v37, v37
    v_exp_f32 v38, v38
    v_exp_f32 v39, v39
    v_exp_f32 v8, v8
    v_exp_f32 v9, v9
    v_smfmac_f32_32x32x32_bf16 v[120:135], v[52:55], v[32:39], v5
    ds_read_b128 v[40:43], v153 offset:36864
    v_exp_f32 v10, v10
    v_exp_f32 v11, v11
    v_exp_f32 v12, v12
    v_mfma_f32_32x32x16_bf16 v[24:39], v[44:47], v[68:71], v[88:103]
    ds_read_b128 v[48:51], v157 offset:4096
    v_exp_f32 v13, v13
    v_exp_f32 v14, v14
    v_exp_f32 v15, v15
    v_exp_f32 v16, v16
    v_exp_f32 v17, v17
    v_smfmac_f32_32x32x32_bf16 v[104:119], v[56:59], v[8:15], v5
    ds_read_b128 v[52:55], v157 offset:4608
    v_exp_f32 v18, v18
    v_exp_f32 v19, v19
    v_exp_f32 v20, v20
    v_exp_f32 v21, v21
    v_exp_f32 v22, v22
    v_exp_f32 v23, v23
    v_exp_f32 v24, v24
    v_exp_f32 v25, v25
    v_smfmac_f32_32x32x32_bf16 v[104:119], v[60:63], v[16:23], v5
    s_add_u32 m0, s57, 49152
    v_exp_f32 v26, v26
    v_exp_f32 v27, v27
    v_exp_f32 v28, v28
    s_waitcnt lgkmcnt(0)
    v_mfma_f32_32x32x16_bf16 v[8:23], v[40:43], v[64:67], v[72:87]
    buffer_load_dwordx4 v2, s[8:11], s48 offen sc1 lds
    v_exp_f32 v29, v29
    v_exp_f32 v30, v30
    v_exp_f32 v31, v31
    v_exp_f32 v32, v32
    v_exp_f32 v33, v33
    v_smfmac_f32_32x32x32_bf16 v[120:135], v[56:59], v[24:31], v5
    s_add_u32 m0, s57, 57344
    v_exp_f32 v34, v34
    v_exp_f32 v35, v35
    v_exp_f32 v36, v36
    v_exp_f32 v37, v37
    v_exp_f32 v38, v38
    v_exp_f32 v39, v39
    v_exp_f32 v8, v8
    v_exp_f32 v9, v9
    v_smfmac_f32_32x32x32_bf16 v[120:135], v[60:63], v[32:39], v5
    ds_read_b128 v[44:47], v153 offset:37888
    v_exp_f32 v10, v10
    v_exp_f32 v11, v11
    v_exp_f32 v12, v12
    v_mfma_f32_32x32x16_bf16 v[24:39], v[40:43], v[68:71], v[88:103]
    ds_read_b128 v[56:59], v157 offset:5120
    v_exp_f32 v13, v13
    v_exp_f32 v14, v14
    v_exp_f32 v15, v15
    v_exp_f32 v16, v16
    v_exp_f32 v17, v17
    v_smfmac_f32_32x32x32_bf16 v[104:119], v[48:51], v[8:15], v5
    ds_read_b128 v[60:63], v157 offset:5632
    v_exp_f32 v18, v18
    v_exp_f32 v19, v19
    v_exp_f32 v20, v20
    v_exp_f32 v21, v21
    v_exp_f32 v22, v22
    v_exp_f32 v23, v23
    v_exp_f32 v24, v24
    v_exp_f32 v25, v25
    v_smfmac_f32_32x32x32_bf16 v[104:119], v[52:55], v[16:23], v5
    buffer_load_dwordx4 v2, s[8:11], s49 offen sc1 lds
    v_exp_f32 v26, v26
    v_exp_f32 v27, v27
    v_exp_f32 v28, v28
    s_waitcnt lgkmcnt(0)
    v_mfma_f32_32x32x16_bf16 v[8:23], v[44:47], v[64:67], v[72:87]
    v_exp_f32 v29, v29
    v_exp_f32 v30, v30
    v_exp_f32 v31, v31
    v_exp_f32 v32, v32
    v_exp_f32 v33, v33
    v_smfmac_f32_32x32x32_bf16 v[120:135], v[48:51], v[24:31], v5
    v_exp_f32 v34, v34
    v_exp_f32 v35, v35
    v_exp_f32 v36, v36
    v_exp_f32 v37, v37
    v_exp_f32 v38, v38
    v_exp_f32 v39, v39
    v_exp_f32 v8, v8
    v_exp_f32 v9, v9
    v_smfmac_f32_32x32x32_bf16 v[120:135], v[52:55], v[32:39], v5
    ds_read_b128 v[40:43], v153 offset:38912
    v_exp_f32 v10, v10
    v_exp_f32 v11, v11
    v_exp_f32 v12, v12
    v_mfma_f32_32x32x16_bf16 v[24:39], v[44:47], v[68:71], v[88:103]
    ds_read_b128 v[48:51], v157 offset:6144
    v_exp_f32 v13, v13
    v_exp_f32 v14, v14
    v_exp_f32 v15, v15
    v_exp_f32 v16, v16
    v_exp_f32 v17, v17
    v_smfmac_f32_32x32x32_bf16 v[104:119], v[56:59], v[8:15], v5
    ds_read_b128 v[52:55], v157 offset:6656
    v_exp_f32 v18, v18
    v_exp_f32 v19, v19
    v_exp_f32 v20, v20
    v_exp_f32 v21, v21
    v_exp_f32 v22, v22
    v_exp_f32 v23, v23
    v_exp_f32 v24, v24
    v_exp_f32 v25, v25
    v_smfmac_f32_32x32x32_bf16 v[104:119], v[60:63], v[16:23], v5
    v_exp_f32 v26, v26
    v_exp_f32 v27, v27
    v_exp_f32 v28, v28
    s_waitcnt lgkmcnt(0)
    v_mfma_f32_32x32x16_bf16 v[8:23], v[40:43], v[64:67], v[72:87]
    v_exp_f32 v29, v29
    v_exp_f32 v30, v30
    v_exp_f32 v31, v31
    v_exp_f32 v32, v32
    v_exp_f32 v33, v33
    v_smfmac_f32_32x32x32_bf16 v[120:135], v[56:59], v[24:31], v5
    v_exp_f32 v34, v34
    v_exp_f32 v35, v35
    v_exp_f32 v36, v36
    v_exp_f32 v37, v37
    v_exp_f32 v38, v38
    v_exp_f32 v39, v39
    v_exp_f32 v8, v8
    v_exp_f32 v9, v9
    v_smfmac_f32_32x32x32_bf16 v[120:135], v[60:63], v[32:39], v5
    s_setprio 0
    ds_read_b128 v[44:47], v153 offset:39936
    v_exp_f32 v10, v10
    v_exp_f32 v11, v11
    v_exp_f32 v12, v12
    v_mfma_f32_32x32x16_bf16 v[24:39], v[40:43], v[68:71], v[88:103]
    ds_read_b128 v[56:59], v157 offset:7168
    v_exp_f32 v13, v13
    v_exp_f32 v14, v14
    v_exp_f32 v15, v15
    v_exp_f32 v16, v16
    v_exp_f32 v17, v17
    v_smfmac_f32_32x32x32_bf16 v[104:119], v[48:51], v[8:15], v5
    ds_read_b128 v[60:63], v157 offset:7680
    v_exp_f32 v18, v18
    v_exp_f32 v19, v19
    v_exp_f32 v20, v20
    v_exp_f32 v21, v21
    v_exp_f32 v22, v22
    v_exp_f32 v23, v23
    v_exp_f32 v24, v24
    v_exp_f32 v25, v25
    v_smfmac_f32_32x32x32_bf16 v[104:119], v[52:55], v[16:23], v5
    v_exp_f32 v26, v26
    v_exp_f32 v27, v27
    v_exp_f32 v28, v28
    s_waitcnt lgkmcnt(0)
    v_mfma_f32_32x32x16_bf16 v[8:23], v[44:47], v[64:67], v[72:87]
    v_exp_f32 v29, v29
    v_exp_f32 v30, v30
    v_exp_f32 v31, v31
    v_exp_f32 v32, v32
    v_exp_f32 v33, v33
    v_smfmac_f32_32x32x32_bf16 v[120:135], v[48:51], v[24:31], v5
    v_exp_f32 v34, v34
    v_exp_f32 v35, v35
    v_exp_f32 v36, v36
    v_exp_f32 v37, v37
    v_exp_f32 v38, v38
    v_exp_f32 v39, v39
    v_exp_f32 v8, v8
    v_exp_f32 v9, v9
    v_smfmac_f32_32x32x32_bf16 v[120:135], v[52:55], v[32:39], v5
    s_waitcnt vmcnt(4)
    s_barrier
    s_setprio 1
    ds_read_b128 v[40:43], v152 offset:0
    v_exp_f32 v10, v10
    v_exp_f32 v11, v11
    v_exp_f32 v12, v12
    v_mfma_f32_32x32x16_bf16 v[24:39], v[44:47], v[68:71], v[88:103]
    ds_read_b128 v[48:51], v154 offset:0
    v_exp_f32 v13, v13
    v_exp_f32 v14, v14
    v_exp_f32 v15, v15
    v_exp_f32 v16, v16
    v_exp_f32 v17, v17
    v_smfmac_f32_32x32x32_bf16 v[104:119], v[56:59], v[8:15], v5
    ds_read_b128 v[52:55], v154 offset:512
    v_exp_f32 v18, v18
    v_exp_f32 v19, v19
    v_exp_f32 v20, v20
    v_exp_f32 v21, v21
    v_exp_f32 v22, v22
    v_exp_f32 v23, v23
    v_exp_f32 v24, v24
    v_exp_f32 v25, v25
    v_smfmac_f32_32x32x32_bf16 v[104:119], v[60:63], v[16:23], v5
    v_exp_f32 v26, v26
    v_exp_f32 v27, v27
    v_exp_f32 v28, v28
    s_waitcnt lgkmcnt(0)
    v_mfma_f32_32x32x16_bf16 v[8:23], v[40:43], v[64:67], v[72:87]
    v_exp_f32 v29, v29
    v_exp_f32 v30, v30
    v_exp_f32 v31, v31
    v_exp_f32 v32, v32
    v_exp_f32 v33, v33
    v_smfmac_f32_32x32x32_bf16 v[120:135], v[56:59], v[24:31], v5
    v_exp_f32 v34, v34
    v_exp_f32 v35, v35
    v_exp_f32 v36, v36
    v_exp_f32 v37, v37
    v_exp_f32 v38, v38
    v_exp_f32 v39, v39
    v_exp_f32 v8, v8
    v_exp_f32 v9, v9
    v_smfmac_f32_32x32x32_bf16 v[120:135], v[60:63], v[32:39], v5
    ds_read_b128 v[44:47], v152 offset:1024
    v_exp_f32 v10, v10
    v_exp_f32 v11, v11
    v_exp_f32 v12, v12
    v_mfma_f32_32x32x16_bf16 v[24:39], v[40:43], v[68:71], v[88:103]
    ds_read_b128 v[56:59], v154 offset:1024
    v_exp_f32 v13, v13
    v_exp_f32 v14, v14
    v_exp_f32 v15, v15
    v_exp_f32 v16, v16
    v_exp_f32 v17, v17
    v_smfmac_f32_32x32x32_bf16 v[104:119], v[48:51], v[8:15], v5
    ds_read_b128 v[60:63], v154 offset:1536
    v_exp_f32 v18, v18
    v_exp_f32 v19, v19
    v_exp_f32 v20, v20
    v_exp_f32 v21, v21
    v_exp_f32 v22, v22
    v_exp_f32 v23, v23
    v_exp_f32 v24, v24
    v_exp_f32 v25, v25
    v_smfmac_f32_32x32x32_bf16 v[104:119], v[52:55], v[16:23], v5
    s_add_u32 s52, s54, s56
    s_add_u32 s53, s52, 65536
    v_exp_f32 v26, v26
    v_exp_f32 v27, v27
    v_exp_f32 v28, v28
    s_waitcnt lgkmcnt(0)
    v_mfma_f32_32x32x16_bf16 v[8:23], v[44:47], v[64:67], v[72:87]
    s_add_u32 s48, s52, 4194304
    v_exp_f32 v29, v29
    v_exp_f32 v30, v30
    v_exp_f32 v31, v31
    v_exp_f32 v32, v32
    v_exp_f32 v33, v33
    v_smfmac_f32_32x32x32_bf16 v[120:135], v[48:51], v[24:31], v5
    s_add_u32 s49, s52, 4259840
    s_add_u32 s43, s56, 0x2000
    v_exp_f32 v34, v34
    v_exp_f32 v35, v35
    v_exp_f32 v36, v36
    v_exp_f32 v37, v37
    v_exp_f32 v38, v38
    v_exp_f32 v39, v39
    v_exp_f32 v8, v8
    v_exp_f32 v9, v9
    v_smfmac_f32_32x32x32_bf16 v[120:135], v[52:55], v[32:39], v5
    ds_read_b128 v[40:43], v152 offset:2048
    v_exp_f32 v10, v10
    v_exp_f32 v11, v11
    v_exp_f32 v12, v12
    v_mfma_f32_32x32x16_bf16 v[24:39], v[44:47], v[68:71], v[88:103]
    ds_read_b128 v[48:51], v154 offset:2048
    v_exp_f32 v13, v13
    v_exp_f32 v14, v14
    v_exp_f32 v15, v15
    v_exp_f32 v16, v16
    v_exp_f32 v17, v17
    v_smfmac_f32_32x32x32_bf16 v[104:119], v[56:59], v[8:15], v5
    ds_read_b128 v[52:55], v154 offset:2560
    v_exp_f32 v18, v18
    v_exp_f32 v19, v19
    v_exp_f32 v20, v20
    v_exp_f32 v21, v21
    v_exp_f32 v22, v22
    v_exp_f32 v23, v23
    v_exp_f32 v24, v24
    v_exp_f32 v25, v25
    v_smfmac_f32_32x32x32_bf16 v[104:119], v[60:63], v[16:23], v5
    s_and_b32 s43, s43, 0x6000
    s_and_b32 s56, s56, 0x8000
    v_exp_f32 v26, v26
    v_exp_f32 v27, v27
    v_exp_f32 v28, v28
    s_waitcnt lgkmcnt(0)
    v_mfma_f32_32x32x16_bf16 v[8:23], v[40:43], v[64:67], v[72:87]
    s_or_b32 s56, s56, s43
    v_exp_f32 v29, v29
    v_exp_f32 v30, v30
    v_exp_f32 v31, v31
    v_exp_f32 v32, v32
    v_exp_f32 v33, v33
    v_smfmac_f32_32x32x32_bf16 v[120:135], v[56:59], v[24:31], v5
    s_add_u32 m0, s57, 65536
    v_exp_f32 v34, v34
    v_exp_f32 v35, v35
    v_exp_f32 v36, v36
    v_exp_f32 v37, v37
    v_exp_f32 v38, v38
    v_exp_f32 v39, v39
    v_exp_f32 v8, v8
    v_exp_f32 v9, v9
    v_smfmac_f32_32x32x32_bf16 v[120:135], v[60:63], v[32:39], v5
    ds_read_b128 v[44:47], v152 offset:3072
    v_exp_f32 v10, v10
    v_exp_f32 v11, v11
    v_exp_f32 v12, v12
    v_mfma_f32_32x32x16_bf16 v[24:39], v[40:43], v[68:71], v[88:103]
    ds_read_b128 v[56:59], v154 offset:3072
    v_exp_f32 v13, v13
    v_exp_f32 v14, v14
    v_exp_f32 v15, v15
    v_exp_f32 v16, v16
    v_exp_f32 v17, v17
    v_smfmac_f32_32x32x32_bf16 v[104:119], v[48:51], v[8:15], v5
    ds_read_b128 v[60:63], v154 offset:3584
    v_exp_f32 v18, v18
    v_exp_f32 v19, v19
    v_exp_f32 v20, v20
    v_exp_f32 v21, v21
    v_exp_f32 v22, v22
    v_exp_f32 v23, v23
    v_exp_f32 v24, v24
    v_exp_f32 v25, v25
    v_smfmac_f32_32x32x32_bf16 v[104:119], v[52:55], v[16:23], v5
    buffer_load_dwordx4 v2, s[8:11], s52 offen sc1 lds
    v_exp_f32 v26, v26
    v_exp_f32 v27, v27
    v_exp_f32 v28, v28
    s_waitcnt lgkmcnt(0)
    v_mfma_f32_32x32x16_bf16 v[8:23], v[44:47], v[64:67], v[72:87]
    s_add_u32 m0, s57, 73728
    v_exp_f32 v29, v29
    v_exp_f32 v30, v30
    v_exp_f32 v31, v31
    v_exp_f32 v32, v32
    v_exp_f32 v33, v33
    v_smfmac_f32_32x32x32_bf16 v[120:135], v[48:51], v[24:31], v5
    buffer_load_dwordx4 v2, s[8:11], s53 offen sc1 lds
    v_exp_f32 v34, v34
    v_exp_f32 v35, v35
    v_exp_f32 v36, v36
    v_exp_f32 v37, v37
    v_exp_f32 v38, v38
    v_exp_f32 v39, v39
    v_exp_f32 v8, v8
    v_exp_f32 v9, v9
    v_smfmac_f32_32x32x32_bf16 v[120:135], v[52:55], v[32:39], v5
    ds_read_b128 v[40:43], v152 offset:4096
    v_exp_f32 v10, v10
    v_exp_f32 v11, v11
    v_exp_f32 v12, v12
    v_mfma_f32_32x32x16_bf16 v[24:39], v[44:47], v[68:71], v[88:103]
    ds_read_b128 v[48:51], v154 offset:4096
    v_exp_f32 v13, v13
    v_exp_f32 v14, v14
    v_exp_f32 v15, v15
    v_exp_f32 v16, v16
    v_exp_f32 v17, v17
    v_smfmac_f32_32x32x32_bf16 v[104:119], v[56:59], v[8:15], v5
    ds_read_b128 v[52:55], v154 offset:4608
    v_exp_f32 v18, v18
    v_exp_f32 v19, v19
    v_exp_f32 v20, v20
    v_exp_f32 v21, v21
    v_exp_f32 v22, v22
    v_exp_f32 v23, v23
    v_exp_f32 v24, v24
    v_exp_f32 v25, v25
    v_smfmac_f32_32x32x32_bf16 v[104:119], v[60:63], v[16:23], v5
    s_add_u32 m0, s57, 81920
    v_exp_f32 v26, v26
    v_exp_f32 v27, v27
    v_exp_f32 v28, v28
    s_waitcnt lgkmcnt(0)
    v_mfma_f32_32x32x16_bf16 v[8:23], v[40:43], v[64:67], v[72:87]
    buffer_load_dwordx4 v2, s[8:11], s48 offen sc1 lds
    v_exp_f32 v29, v29
    v_exp_f32 v30, v30
    v_exp_f32 v31, v31
    v_exp_f32 v32, v32
    v_exp_f32 v33, v33
    v_smfmac_f32_32x32x32_bf16 v[120:135], v[56:59], v[24:31], v5
    s_add_u32 m0, s57, 90112
    v_exp_f32 v34, v34
    v_exp_f32 v35, v35
    v_exp_f32 v36, v36
    v_exp_f32 v37, v37
    v_exp_f32 v38, v38
    v_exp_f32 v39, v39
    v_exp_f32 v8, v8
    v_exp_f32 v9, v9
    v_smfmac_f32_32x32x32_bf16 v[120:135], v[60:63], v[32:39], v5
    ds_read_b128 v[44:47], v152 offset:5120
    v_exp_f32 v10, v10
    v_exp_f32 v11, v11
    v_exp_f32 v12, v12
    v_mfma_f32_32x32x16_bf16 v[24:39], v[40:43], v[68:71], v[88:103]
    ds_read_b128 v[56:59], v154 offset:5120
    v_exp_f32 v13, v13
    v_exp_f32 v14, v14
    v_exp_f32 v15, v15
    v_exp_f32 v16, v16
    v_exp_f32 v17, v17
    v_smfmac_f32_32x32x32_bf16 v[104:119], v[48:51], v[8:15], v5
    ds_read_b128 v[60:63], v154 offset:5632
    v_exp_f32 v18, v18
    v_exp_f32 v19, v19
    v_exp_f32 v20, v20
    v_exp_f32 v21, v21
    v_exp_f32 v22, v22
    v_exp_f32 v23, v23
    v_exp_f32 v24, v24
    v_exp_f32 v25, v25
    v_smfmac_f32_32x32x32_bf16 v[104:119], v[52:55], v[16:23], v5
    buffer_load_dwordx4 v2, s[8:11], s49 offen sc1 lds
    v_exp_f32 v26, v26
    v_exp_f32 v27, v27
    v_exp_f32 v28, v28
    s_waitcnt lgkmcnt(0)
    v_mfma_f32_32x32x16_bf16 v[8:23], v[44:47], v[64:67], v[72:87]
    v_exp_f32 v29, v29
    v_exp_f32 v30, v30
    v_exp_f32 v31, v31
    v_exp_f32 v32, v32
    v_exp_f32 v33, v33
    v_smfmac_f32_32x32x32_bf16 v[120:135], v[48:51], v[24:31], v5
    v_exp_f32 v34, v34
    v_exp_f32 v35, v35
    v_exp_f32 v36, v36
    v_exp_f32 v37, v37
    v_exp_f32 v38, v38
    v_exp_f32 v39, v39
    v_exp_f32 v8, v8
    v_exp_f32 v9, v9
    v_smfmac_f32_32x32x32_bf16 v[120:135], v[52:55], v[32:39], v5
    ds_read_b128 v[40:43], v152 offset:6144
    v_exp_f32 v10, v10
    v_exp_f32 v11, v11
    v_exp_f32 v12, v12
    v_mfma_f32_32x32x16_bf16 v[24:39], v[44:47], v[68:71], v[88:103]
    ds_read_b128 v[48:51], v154 offset:6144
    v_exp_f32 v13, v13
    v_exp_f32 v14, v14
    v_exp_f32 v15, v15
    v_exp_f32 v16, v16
    v_exp_f32 v17, v17
    v_smfmac_f32_32x32x32_bf16 v[104:119], v[56:59], v[8:15], v5
    ds_read_b128 v[52:55], v154 offset:6656
    v_exp_f32 v18, v18
    v_exp_f32 v19, v19
    v_exp_f32 v20, v20
    v_exp_f32 v21, v21
    v_exp_f32 v22, v22
    v_exp_f32 v23, v23
    v_exp_f32 v24, v24
    v_exp_f32 v25, v25
    v_smfmac_f32_32x32x32_bf16 v[104:119], v[60:63], v[16:23], v5
    v_exp_f32 v26, v26
    v_exp_f32 v27, v27
    v_exp_f32 v28, v28
    s_waitcnt lgkmcnt(0)
    v_mfma_f32_32x32x16_bf16 v[8:23], v[40:43], v[64:67], v[72:87]
    v_exp_f32 v29, v29
    v_exp_f32 v30, v30
    v_exp_f32 v31, v31
    v_exp_f32 v32, v32
    v_exp_f32 v33, v33
    v_smfmac_f32_32x32x32_bf16 v[120:135], v[56:59], v[24:31], v5
    v_exp_f32 v34, v34
    v_exp_f32 v35, v35
    v_exp_f32 v36, v36
    v_exp_f32 v37, v37
    v_exp_f32 v38, v38
    v_exp_f32 v39, v39
    v_exp_f32 v8, v8
    v_exp_f32 v9, v9
    v_smfmac_f32_32x32x32_bf16 v[120:135], v[60:63], v[32:39], v5
    s_setprio 0
    ds_read_b128 v[44:47], v152 offset:7168
    v_exp_f32 v10, v10
    v_exp_f32 v11, v11
    v_exp_f32 v12, v12
    v_mfma_f32_32x32x16_bf16 v[24:39], v[40:43], v[68:71], v[88:103]
    ds_read_b128 v[56:59], v154 offset:7168
    v_exp_f32 v13, v13
    v_exp_f32 v14, v14
    v_exp_f32 v15, v15
    v_exp_f32 v16, v16
    v_exp_f32 v17, v17
    v_smfmac_f32_32x32x32_bf16 v[104:119], v[48:51], v[8:15], v5
    ds_read_b128 v[60:63], v154 offset:7680
    v_exp_f32 v18, v18
    v_exp_f32 v19, v19
    v_exp_f32 v20, v20
    v_exp_f32 v21, v21
    v_exp_f32 v22, v22
    v_exp_f32 v23, v23
    v_exp_f32 v24, v24
    v_exp_f32 v25, v25
    v_smfmac_f32_32x32x32_bf16 v[104:119], v[52:55], v[16:23], v5
    v_exp_f32 v26, v26
    v_exp_f32 v27, v27
    v_exp_f32 v28, v28
    s_waitcnt lgkmcnt(0)
    v_mfma_f32_32x32x16_bf16 v[8:23], v[44:47], v[64:67], v[72:87]
    v_exp_f32 v29, v29
    v_exp_f32 v30, v30
    v_exp_f32 v31, v31
    v_exp_f32 v32, v32
    v_exp_f32 v33, v33
    v_smfmac_f32_32x32x32_bf16 v[120:135], v[48:51], v[24:31], v5
    v_exp_f32 v34, v34
    v_exp_f32 v35, v35
    v_exp_f32 v36, v36
    v_exp_f32 v37, v37
    v_exp_f32 v38, v38
    v_exp_f32 v39, v39
    v_exp_f32 v8, v8
    v_exp_f32 v9, v9
    v_smfmac_f32_32x32x32_bf16 v[120:135], v[52:55], v[32:39], v5
    s_waitcnt vmcnt(4)
    s_barrier
    s_setprio 1
    ds_read_b128 v[40:43], v152 offset:32768
    v_exp_f32 v10, v10
    v_exp_f32 v11, v11
    v_exp_f32 v12, v12
    v_mfma_f32_32x32x16_bf16 v[24:39], v[44:47], v[68:71], v[88:103]
    ds_read_b128 v[48:51], v155 offset:0
    v_exp_f32 v13, v13
    v_exp_f32 v14, v14
    v_exp_f32 v15, v15
    v_exp_f32 v16, v16
    v_exp_f32 v17, v17
    v_smfmac_f32_32x32x32_bf16 v[104:119], v[56:59], v[8:15], v5
    ds_read_b128 v[52:55], v155 offset:512
    v_exp_f32 v18, v18
    v_exp_f32 v19, v19
    v_exp_f32 v20, v20
    v_exp_f32 v21, v21
    v_exp_f32 v22, v22
    v_exp_f32 v23, v23
    v_exp_f32 v24, v24
    v_exp_f32 v25, v25
    v_smfmac_f32_32x32x32_bf16 v[104:119], v[60:63], v[16:23], v5
    v_exp_f32 v26, v26
    v_exp_f32 v27, v27
    v_exp_f32 v28, v28
    s_waitcnt lgkmcnt(0)
    v_mfma_f32_32x32x16_bf16 v[8:23], v[40:43], v[64:67], v[72:87]
    v_exp_f32 v29, v29
    v_exp_f32 v30, v30
    v_exp_f32 v31, v31
    v_exp_f32 v32, v32
    v_exp_f32 v33, v33
    v_smfmac_f32_32x32x32_bf16 v[120:135], v[56:59], v[24:31], v5
    v_exp_f32 v34, v34
    v_exp_f32 v35, v35
    v_exp_f32 v36, v36
    v_exp_f32 v37, v37
    v_exp_f32 v38, v38
    v_exp_f32 v39, v39
    v_exp_f32 v8, v8
    v_exp_f32 v9, v9
    v_smfmac_f32_32x32x32_bf16 v[120:135], v[60:63], v[32:39], v5
    ds_read_b128 v[44:47], v152 offset:33792
    v_exp_f32 v10, v10
    v_exp_f32 v11, v11
    v_exp_f32 v12, v12
    v_mfma_f32_32x32x16_bf16 v[24:39], v[40:43], v[68:71], v[88:103]
    ds_read_b128 v[56:59], v155 offset:1024
    v_exp_f32 v13, v13
    v_exp_f32 v14, v14
    v_exp_f32 v15, v15
    v_exp_f32 v16, v16
    v_exp_f32 v17, v17
    v_smfmac_f32_32x32x32_bf16 v[104:119], v[48:51], v[8:15], v5
    ds_read_b128 v[60:63], v155 offset:1536
    v_exp_f32 v18, v18
    v_exp_f32 v19, v19
    v_exp_f32 v20, v20
    v_exp_f32 v21, v21
    v_exp_f32 v22, v22
    v_exp_f32 v23, v23
    v_exp_f32 v24, v24
    v_exp_f32 v25, v25
    v_smfmac_f32_32x32x32_bf16 v[104:119], v[52:55], v[16:23], v5
    s_add_u32 s52, s54, s56
    s_add_u32 s53, s52, 65536
    v_exp_f32 v26, v26
    v_exp_f32 v27, v27
    v_exp_f32 v28, v28
    s_waitcnt lgkmcnt(0)
    v_mfma_f32_32x32x16_bf16 v[8:23], v[44:47], v[64:67], v[72:87]
    s_add_u32 s48, s52, 4194304
    v_exp_f32 v29, v29
    v_exp_f32 v30, v30
    v_exp_f32 v31, v31
    v_exp_f32 v32, v32
    v_exp_f32 v33, v33
    v_smfmac_f32_32x32x32_bf16 v[120:135], v[48:51], v[24:31], v5
    s_add_u32 s49, s52, 4259840
    s_add_u32 s43, s56, 0x2000
    v_exp_f32 v34, v34
    v_exp_f32 v35, v35
    v_exp_f32 v36, v36
    v_exp_f32 v37, v37
    v_exp_f32 v38, v38
    v_exp_f32 v39, v39
    v_exp_f32 v8, v8
    v_exp_f32 v9, v9
    v_smfmac_f32_32x32x32_bf16 v[120:135], v[52:55], v[32:39], v5
    ds_read_b128 v[40:43], v152 offset:34816
    v_exp_f32 v10, v10
    v_exp_f32 v11, v11
    v_exp_f32 v12, v12
    v_mfma_f32_32x32x16_bf16 v[24:39], v[44:47], v[68:71], v[88:103]
    ds_read_b128 v[48:51], v155 offset:2048
    v_exp_f32 v13, v13
    v_exp_f32 v14, v14
    v_exp_f32 v15, v15
    v_exp_f32 v16, v16
    v_exp_f32 v17, v17
    v_smfmac_f32_32x32x32_bf16 v[104:119], v[56:59], v[8:15], v5
    ds_read_b128 v[52:55], v155 offset:2560
    v_exp_f32 v18, v18
    v_exp_f32 v19, v19
    v_exp_f32 v20, v20
    v_exp_f32 v21, v21
    v_exp_f32 v22, v22
    v_exp_f32 v23, v23
    v_exp_f32 v24, v24
    v_exp_f32 v25, v25
    v_smfmac_f32_32x32x32_bf16 v[104:119], v[60:63], v[16:23], v5
    s_and_b32 s43, s43, 0x6000
    s_and_b32 s56, s56, 0x8000
    v_exp_f32 v26, v26
    v_exp_f32 v27, v27
    v_exp_f32 v28, v28
    s_waitcnt lgkmcnt(0)
    v_mfma_f32_32x32x16_bf16 v[8:23], v[40:43], v[64:67], v[72:87]
    s_or_b32 s56, s56, s43
    v_exp_f32 v29, v29
    v_exp_f32 v30, v30
    v_exp_f32 v31, v31
    v_exp_f32 v32, v32
    v_exp_f32 v33, v33
    v_smfmac_f32_32x32x32_bf16 v[120:135], v[56:59], v[24:31], v5
    s_add_u32 m0, s57, 98304
    v_exp_f32 v34, v34
    v_exp_f32 v35, v35
    v_exp_f32 v36, v36
    v_exp_f32 v37, v37
    v_exp_f32 v38, v38
    v_exp_f32 v39, v39
    v_exp_f32 v8, v8
    v_exp_f32 v9, v9
    v_smfmac_f32_32x32x32_bf16 v[120:135], v[60:63], v[32:39], v5
    ds_read_b128 v[44:47], v152 offset:35840
    v_exp_f32 v10, v10
    v_exp_f32 v11, v11
    v_exp_f32 v12, v12
    v_mfma_f32_32x32x16_bf16 v[24:39], v[40:43], v[68:71], v[88:103]
    ds_read_b128 v[56:59], v155 offset:3072
    v_exp_f32 v13, v13
    v_exp_f32 v14, v14
    v_exp_f32 v15, v15
    v_exp_f32 v16, v16
    v_exp_f32 v17, v17
    v_smfmac_f32_32x32x32_bf16 v[104:119], v[48:51], v[8:15], v5
    ds_read_b128 v[60:63], v155 offset:3584
    v_exp_f32 v18, v18
    v_exp_f32 v19, v19
    v_exp_f32 v20, v20
    v_exp_f32 v21, v21
    v_exp_f32 v22, v22
    v_exp_f32 v23, v23
    v_exp_f32 v24, v24
    v_exp_f32 v25, v25
    v_smfmac_f32_32x32x32_bf16 v[104:119], v[52:55], v[16:23], v5
    buffer_load_dwordx4 v2, s[8:11], s52 offen sc1 lds
    v_exp_f32 v26, v26
    v_exp_f32 v27, v27
    v_exp_f32 v28, v28
    s_waitcnt lgkmcnt(0)
    v_mfma_f32_32x32x16_bf16 v[8:23], v[44:47], v[64:67], v[72:87]
    s_add_u32 m0, s57, 106496
    v_exp_f32 v29, v29
    v_exp_f32 v30, v30
    v_exp_f32 v31, v31
    v_exp_f32 v32, v32
    v_exp_f32 v33, v33
    v_smfmac_f32_32x32x32_bf16 v[120:135], v[48:51], v[24:31], v5
    buffer_load_dwordx4 v2, s[8:11], s53 offen sc1 lds
    v_exp_f32 v34, v34
    v_exp_f32 v35, v35
    v_exp_f32 v36, v36
    v_exp_f32 v37, v37
    v_exp_f32 v38, v38
    v_exp_f32 v39, v39
    v_exp_f32 v8, v8
    v_exp_f32 v9, v9
    v_smfmac_f32_32x32x32_bf16 v[120:135], v[52:55], v[32:39], v5
    ds_read_b128 v[40:43], v152 offset:36864
    v_exp_f32 v10, v10
    v_exp_f32 v11, v11
    v_exp_f32 v12, v12
    v_mfma_f32_32x32x16_bf16 v[24:39], v[44:47], v[68:71], v[88:103]
    ds_read_b128 v[48:51], v155 offset:4096
    v_exp_f32 v13, v13
    v_exp_f32 v14, v14
    v_exp_f32 v15, v15
    v_exp_f32 v16, v16
    v_exp_f32 v17, v17
    v_smfmac_f32_32x32x32_bf16 v[104:119], v[56:59], v[8:15], v5
    ds_read_b128 v[52:55], v155 offset:4608
    v_exp_f32 v18, v18
    v_exp_f32 v19, v19
    v_exp_f32 v20, v20
    v_exp_f32 v21, v21
    v_exp_f32 v22, v22
    v_exp_f32 v23, v23
    v_exp_f32 v24, v24
    v_exp_f32 v25, v25
    v_smfmac_f32_32x32x32_bf16 v[104:119], v[60:63], v[16:23], v5
    s_add_u32 m0, s57, 114688
    v_exp_f32 v26, v26
    v_exp_f32 v27, v27
    v_exp_f32 v28, v28
    s_waitcnt lgkmcnt(0)
    v_mfma_f32_32x32x16_bf16 v[8:23], v[40:43], v[64:67], v[72:87]
    buffer_load_dwordx4 v2, s[8:11], s48 offen sc1 lds
    v_exp_f32 v29, v29
    v_exp_f32 v30, v30
    v_exp_f32 v31, v31
    v_exp_f32 v32, v32
    v_exp_f32 v33, v33
    v_smfmac_f32_32x32x32_bf16 v[120:135], v[56:59], v[24:31], v5
    s_add_u32 m0, s57, 122880
    v_exp_f32 v34, v34
    v_exp_f32 v35, v35
    v_exp_f32 v36, v36
    v_exp_f32 v37, v37
    v_exp_f32 v38, v38
    v_exp_f32 v39, v39
    v_exp_f32 v8, v8
    v_exp_f32 v9, v9
    v_smfmac_f32_32x32x32_bf16 v[120:135], v[60:63], v[32:39], v5
    ds_read_b128 v[44:47], v152 offset:37888
    v_exp_f32 v10, v10
    v_exp_f32 v11, v11
    v_exp_f32 v12, v12
    v_mfma_f32_32x32x16_bf16 v[24:39], v[40:43], v[68:71], v[88:103]
    ds_read_b128 v[56:59], v155 offset:5120
    v_exp_f32 v13, v13
    v_exp_f32 v14, v14
    v_exp_f32 v15, v15
    v_exp_f32 v16, v16
    v_exp_f32 v17, v17
    v_smfmac_f32_32x32x32_bf16 v[104:119], v[48:51], v[8:15], v5
    ds_read_b128 v[60:63], v155 offset:5632
    v_exp_f32 v18, v18
    v_exp_f32 v19, v19
    v_exp_f32 v20, v20
    v_exp_f32 v21, v21
    v_exp_f32 v22, v22
    v_exp_f32 v23, v23
    v_exp_f32 v24, v24
    v_exp_f32 v25, v25
    v_smfmac_f32_32x32x32_bf16 v[104:119], v[52:55], v[16:23], v5
    buffer_load_dwordx4 v2, s[8:11], s49 offen sc1 lds
    v_exp_f32 v26, v26
    v_exp_f32 v27, v27
    v_exp_f32 v28, v28
    s_waitcnt lgkmcnt(0)
    v_mfma_f32_32x32x16_bf16 v[8:23], v[44:47], v[64:67], v[72:87]
    v_exp_f32 v29, v29
    v_exp_f32 v30, v30
    v_exp_f32 v31, v31
    v_exp_f32 v32, v32
    v_exp_f32 v33, v33
    v_smfmac_f32_32x32x32_bf16 v[120:135], v[48:51], v[24:31], v5
    v_exp_f32 v34, v34
    v_exp_f32 v35, v35
    v_exp_f32 v36, v36
    v_exp_f32 v37, v37
    v_exp_f32 v38, v38
    v_exp_f32 v39, v39
    v_exp_f32 v8, v8
    v_exp_f32 v9, v9
    v_smfmac_f32_32x32x32_bf16 v[120:135], v[52:55], v[32:39], v5
    ds_read_b128 v[40:43], v152 offset:38912
    v_exp_f32 v10, v10
    v_exp_f32 v11, v11
    v_exp_f32 v12, v12
    v_mfma_f32_32x32x16_bf16 v[24:39], v[44:47], v[68:71], v[88:103]
    ds_read_b128 v[48:51], v155 offset:6144
    v_exp_f32 v13, v13
    v_exp_f32 v14, v14
    v_exp_f32 v15, v15
    v_exp_f32 v16, v16
    v_exp_f32 v17, v17
    v_smfmac_f32_32x32x32_bf16 v[104:119], v[56:59], v[8:15], v5
    ds_read_b128 v[52:55], v155 offset:6656
    v_exp_f32 v18, v18
    v_exp_f32 v19, v19
    v_exp_f32 v20, v20
    v_exp_f32 v21, v21
    v_exp_f32 v22, v22
    v_exp_f32 v23, v23
    v_exp_f32 v24, v24
    v_exp_f32 v25, v25
    v_smfmac_f32_32x32x32_bf16 v[104:119], v[60:63], v[16:23], v5
    v_exp_f32 v26, v26
    v_exp_f32 v27, v27
    v_exp_f32 v28, v28
    s_waitcnt lgkmcnt(0)
    v_mfma_f32_32x32x16_bf16 v[8:23], v[40:43], v[64:67], v[72:87]
    v_exp_f32 v29, v29
    v_exp_f32 v30, v30
    v_exp_f32 v31, v31
    v_exp_f32 v32, v32
    v_exp_f32 v33, v33
    v_smfmac_f32_32x32x32_bf16 v[120:135], v[56:59], v[24:31], v5
    v_exp_f32 v34, v34
    v_exp_f32 v35, v35
    v_exp_f32 v36, v36
    v_exp_f32 v37, v37
    v_exp_f32 v38, v38
    v_exp_f32 v39, v39
    v_exp_f32 v8, v8
    v_exp_f32 v9, v9
    v_smfmac_f32_32x32x32_bf16 v[120:135], v[60:63], v[32:39], v5
    s_setprio 0
    ds_read_b128 v[44:47], v152 offset:39936
    v_exp_f32 v10, v10
    v_exp_f32 v11, v11
    v_exp_f32 v12, v12
    v_mfma_f32_32x32x16_bf16 v[24:39], v[40:43], v[68:71], v[88:103]
    ds_read_b128 v[56:59], v155 offset:7168
    v_exp_f32 v13, v13
    v_exp_f32 v14, v14
    v_exp_f32 v15, v15
    v_exp_f32 v16, v16
    v_exp_f32 v17, v17
    v_smfmac_f32_32x32x32_bf16 v[104:119], v[48:51], v[8:15], v5
    ds_read_b128 v[60:63], v155 offset:7680
    v_exp_f32 v18, v18
    v_exp_f32 v19, v19
    v_exp_f32 v20, v20
    v_exp_f32 v21, v21
    v_exp_f32 v22, v22
    v_exp_f32 v23, v23
    v_exp_f32 v24, v24
    v_exp_f32 v25, v25
    v_smfmac_f32_32x32x32_bf16 v[104:119], v[52:55], v[16:23], v5
    v_exp_f32 v26, v26
    v_exp_f32 v27, v27
    v_exp_f32 v28, v28
    s_waitcnt lgkmcnt(0)
    v_mfma_f32_32x32x16_bf16 v[8:23], v[44:47], v[64:67], v[72:87]
    v_exp_f32 v29, v29
    v_exp_f32 v30, v30
    v_exp_f32 v31, v31
    v_exp_f32 v32, v32
    v_exp_f32 v33, v33
    v_smfmac_f32_32x32x32_bf16 v[120:135], v[48:51], v[24:31], v5
    v_exp_f32 v34, v34
    v_exp_f32 v35, v35
    v_exp_f32 v36, v36
    v_exp_f32 v37, v37
    v_exp_f32 v38, v38
    v_exp_f32 v39, v39
    v_exp_f32 v8, v8
    v_exp_f32 v9, v9
    v_smfmac_f32_32x32x32_bf16 v[120:135], v[52:55], v[32:39], v5
    s_waitcnt vmcnt(4) lgkmcnt(0)
    s_barrier
    s_setprio 1
    ds_read_b128 v[40:43], v153 offset:0
    v_exp_f32 v10, v10
    v_exp_f32 v11, v11
    v_exp_f32 v12, v12
    v_mfma_f32_32x32x16_bf16 v[24:39], v[44:47], v[68:71], v[88:103]
    ds_read_b128 v[48:51], v156 offset:0
    v_exp_f32 v13, v13
    v_exp_f32 v14, v14
    v_exp_f32 v15, v15
    v_exp_f32 v16, v16
    v_exp_f32 v17, v17
    v_smfmac_f32_32x32x32_bf16 v[104:119], v[56:59], v[8:15], v5
    ds_read_b128 v[52:55], v156 offset:512
    v_exp_f32 v18, v18
    v_exp_f32 v19, v19
    v_exp_f32 v20, v20
    v_exp_f32 v21, v21
    v_exp_f32 v22, v22
    v_exp_f32 v23, v23
    v_exp_f32 v24, v24
    v_exp_f32 v25, v25
    v_smfmac_f32_32x32x32_bf16 v[104:119], v[60:63], v[16:23], v5
    v_exp_f32 v26, v26
    v_exp_f32 v27, v27
    v_exp_f32 v28, v28
    s_waitcnt lgkmcnt(0)
    v_mfma_f32_32x32x16_bf16 v[8:23], v[40:43], v[64:67], v[72:87]
    v_exp_f32 v29, v29
    v_exp_f32 v30, v30
    v_exp_f32 v31, v31
    v_exp_f32 v32, v32
    v_exp_f32 v33, v33
    v_smfmac_f32_32x32x32_bf16 v[120:135], v[56:59], v[24:31], v5
    v_exp_f32 v34, v34
    v_exp_f32 v35, v35
    v_exp_f32 v36, v36
    v_exp_f32 v37, v37
    v_exp_f32 v38, v38
    v_exp_f32 v39, v39
    v_exp_f32 v8, v8
    v_exp_f32 v9, v9
    v_smfmac_f32_32x32x32_bf16 v[120:135], v[60:63], v[32:39], v5
    ds_read_b128 v[44:47], v153 offset:1024
    v_exp_f32 v10, v10
    v_exp_f32 v11, v11
    v_exp_f32 v12, v12
    v_mfma_f32_32x32x16_bf16 v[24:39], v[40:43], v[68:71], v[88:103]
    ds_read_b128 v[56:59], v156 offset:1024
    v_exp_f32 v13, v13
    v_exp_f32 v14, v14
    v_exp_f32 v15, v15
    v_exp_f32 v16, v16
    v_exp_f32 v17, v17
    v_smfmac_f32_32x32x32_bf16 v[104:119], v[48:51], v[8:15], v5
    ds_read_b128 v[60:63], v156 offset:1536
    v_exp_f32 v18, v18
    v_exp_f32 v19, v19
    v_exp_f32 v20, v20
    v_exp_f32 v21, v21
    v_exp_f32 v22, v22
    v_exp_f32 v23, v23
    v_exp_f32 v24, v24
    v_exp_f32 v25, v25
    v_smfmac_f32_32x32x32_bf16 v[104:119], v[52:55], v[16:23], v5
    s_add_u32 m0, s57, 0
    v_exp_f32 v26, v26
    v_exp_f32 v27, v27
    v_exp_f32 v28, v28
    s_waitcnt lgkmcnt(0)
    v_mfma_f32_32x32x16_bf16 v[8:23], v[44:47], v[64:67], v[72:87]
    buffer_load_dwordx4 v141, s[16:19], s50 offen lds
    v_exp_f32 v29, v29
    v_exp_f32 v30, v30
    v_exp_f32 v31, v31
    v_exp_f32 v32, v32
    v_exp_f32 v33, v33
    v_smfmac_f32_32x32x32_bf16 v[120:135], v[48:51], v[24:31], v5
    s_add_u32 s50, s50, 65536
    s_add_u32 m0, s57, 8192
    v_exp_f32 v34, v34
    v_exp_f32 v35, v35
    v_exp_f32 v36, v36
    v_exp_f32 v37, v37
    v_exp_f32 v38, v38
    v_exp_f32 v39, v39
    v_exp_f32 v8, v8
    v_exp_f32 v9, v9
    v_smfmac_f32_32x32x32_bf16 v[120:135], v[52:55], v[32:39], v5
    ds_read_b128 v[40:43], v153 offset:2048
    v_exp_f32 v10, v10
    v_exp_f32 v11, v11
    v_exp_f32 v12, v12
    v_mfma_f32_32x32x16_bf16 v[24:39], v[44:47], v[68:71], v[88:103]
    ds_read_b128 v[48:51], v156 offset:2048
    v_exp_f32 v13, v13
    v_exp_f32 v14, v14
    v_exp_f32 v15, v15
    v_exp_f32 v16, v16
    v_exp_f32 v17, v17
    v_smfmac_f32_32x32x32_bf16 v[104:119], v[56:59], v[8:15], v5
    ds_read_b128 v[52:55], v156 offset:2560
    v_exp_f32 v18, v18
    v_exp_f32 v19, v19
    v_exp_f32 v20, v20
    v_exp_f32 v21, v21
    v_exp_f32 v22, v22
    v_exp_f32 v23, v23
    v_exp_f32 v24, v24
    v_exp_f32 v25, v25
    v_smfmac_f32_32x32x32_bf16 v[104:119], v[60:63], v[16:23], v5
    buffer_load_dwordx4 v141, s[16:19], s50 offen lds
    v_exp_f32 v26, v26
    v_exp_f32 v27, v27
    v_exp_f32 v28, v28
    s_waitcnt lgkmcnt(0)
    v_mfma_f32_32x32x16_bf16 v[8:23], v[40:43], v[64:67], v[72:87]
    s_add_u32 s50, s50, 65536
    v_exp_f32 v29, v29
    v_exp_f32 v30, v30
    v_exp_f32 v31, v31
    v_exp_f32 v32, v32
    v_exp_f32 v33, v33
    v_smfmac_f32_32x32x32_bf16 v[120:135], v[56:59], v[24:31], v5
    s_add_u32 m0, s57, 16384
    v_exp_f32 v34, v34
    v_exp_f32 v35, v35
    v_exp_f32 v36, v36
    v_exp_f32 v37, v37
    v_exp_f32 v38, v38
    v_exp_f32 v39, v39
    v_exp_f32 v8, v8
    v_exp_f32 v9, v9
    v_smfmac_f32_32x32x32_bf16 v[120:135], v[60:63], v[32:39], v5
    ds_read_b128 v[44:47], v153 offset:3072
    v_exp_f32 v10, v10
    v_exp_f32 v11, v11
    v_exp_f32 v12, v12
    v_mfma_f32_32x32x16_bf16 v[24:39], v[40:43], v[68:71], v[88:103]
    ds_read_b128 v[56:59], v156 offset:3072
    v_exp_f32 v13, v13
    v_exp_f32 v14, v14
    v_exp_f32 v15, v15
    v_exp_f32 v16, v16
    v_exp_f32 v17, v17
    v_smfmac_f32_32x32x32_bf16 v[104:119], v[48:51], v[8:15], v5
    ds_read_b128 v[60:63], v156 offset:3584
    v_exp_f32 v18, v18
    v_exp_f32 v19, v19
    v_exp_f32 v20, v20
    v_exp_f32 v21, v21
    v_exp_f32 v22, v22
    v_exp_f32 v23, v23
    v_exp_f32 v24, v24
    v_exp_f32 v25, v25
    v_smfmac_f32_32x32x32_bf16 v[104:119], v[52:55], v[16:23], v5
    buffer_load_dwordx4 v141, s[16:19], s50 offen lds
    v_exp_f32 v26, v26
    v_exp_f32 v27, v27
    v_exp_f32 v28, v28
    s_waitcnt lgkmcnt(0)
    v_mfma_f32_32x32x16_bf16 v[8:23], v[44:47], v[64:67], v[72:87]
    s_add_u32 s50, s50, 65536
    v_exp_f32 v29, v29
    v_exp_f32 v30, v30
    v_exp_f32 v31, v31
    v_exp_f32 v32, v32
    v_exp_f32 v33, v33
    v_smfmac_f32_32x32x32_bf16 v[120:135], v[48:51], v[24:31], v5
    s_add_u32 m0, s57, 24576
    v_exp_f32 v34, v34
    v_exp_f32 v35, v35
    v_exp_f32 v36, v36
    v_exp_f32 v37, v37
    v_exp_f32 v38, v38
    v_exp_f32 v39, v39
    v_exp_f32 v8, v8
    v_exp_f32 v9, v9
    v_smfmac_f32_32x32x32_bf16 v[120:135], v[52:55], v[32:39], v5
    ds_read_b128 v[40:43], v153 offset:4096
    v_exp_f32 v10, v10
    v_exp_f32 v11, v11
    v_exp_f32 v12, v12
    v_mfma_f32_32x32x16_bf16 v[24:39], v[44:47], v[68:71], v[88:103]
    ds_read_b128 v[48:51], v156 offset:4096
    v_exp_f32 v13, v13
    v_exp_f32 v14, v14
    v_exp_f32 v15, v15
    v_exp_f32 v16, v16
    v_exp_f32 v17, v17
    v_smfmac_f32_32x32x32_bf16 v[104:119], v[56:59], v[8:15], v5
    ds_read_b128 v[52:55], v156 offset:4608
    v_exp_f32 v18, v18
    v_exp_f32 v19, v19
    v_exp_f32 v20, v20
    v_exp_f32 v21, v21
    v_exp_f32 v22, v22
    v_exp_f32 v23, v23
    v_exp_f32 v24, v24
    v_exp_f32 v25, v25
    v_smfmac_f32_32x32x32_bf16 v[104:119], v[60:63], v[16:23], v5
    buffer_load_dwordx4 v141, s[16:19], s50 offen lds
    v_exp_f32 v26, v26
    v_exp_f32 v27, v27
    v_exp_f32 v28, v28
    s_waitcnt lgkmcnt(0)
    v_mfma_f32_32x32x16_bf16 v[8:23], v[40:43], v[64:67], v[72:87]
    s_add_u32 s50, s50, 65536
    v_exp_f32 v29, v29
    v_exp_f32 v30, v30
    v_exp_f32 v31, v31
    v_exp_f32 v32, v32
    v_exp_f32 v33, v33
    v_smfmac_f32_32x32x32_bf16 v[120:135], v[56:59], v[24:31], v5
    s_add_u32 m0, s57, 32768
    v_exp_f32 v34, v34
    v_exp_f32 v35, v35
    v_exp_f32 v36, v36
    v_exp_f32 v37, v37
    v_exp_f32 v38, v38
    v_exp_f32 v39, v39
    v_exp_f32 v8, v8
    v_exp_f32 v9, v9
    v_smfmac_f32_32x32x32_bf16 v[120:135], v[60:63], v[32:39], v5
    ds_read_b128 v[44:47], v153 offset:5120
    v_exp_f32 v10, v10
    v_exp_f32 v11, v11
    v_exp_f32 v12, v12
    v_mfma_f32_32x32x16_bf16 v[24:39], v[40:43], v[68:71], v[88:103]
    ds_read_b128 v[56:59], v156 offset:5120
    v_exp_f32 v13, v13
    v_exp_f32 v14, v14
    v_exp_f32 v15, v15
    v_exp_f32 v16, v16
    v_exp_f32 v17, v17
    v_smfmac_f32_32x32x32_bf16 v[104:119], v[48:51], v[8:15], v5
    ds_read_b128 v[60:63], v156 offset:5632
    v_exp_f32 v18, v18
    v_exp_f32 v19, v19
    v_exp_f32 v20, v20
    v_exp_f32 v21, v21
    v_exp_f32 v22, v22
    v_exp_f32 v23, v23
    v_exp_f32 v24, v24
    v_exp_f32 v25, v25
    v_smfmac_f32_32x32x32_bf16 v[104:119], v[52:55], v[16:23], v5
    buffer_load_dwordx4 v141, s[16:19], s50 offen lds
    v_exp_f32 v26, v26
    v_exp_f32 v27, v27
    v_exp_f32 v28, v28
    s_waitcnt lgkmcnt(0)
    v_mfma_f32_32x32x16_bf16 v[8:23], v[44:47], v[64:67], v[72:87]
    s_add_u32 s50, s50, 65536
    v_exp_f32 v29, v29
    v_exp_f32 v30, v30
    v_exp_f32 v31, v31
    v_exp_f32 v32, v32
    v_exp_f32 v33, v33
    v_smfmac_f32_32x32x32_bf16 v[120:135], v[48:51], v[24:31], v5
    s_add_u32 m0, s57, 40960
    v_exp_f32 v34, v34
    v_exp_f32 v35, v35
    v_exp_f32 v36, v36
    v_exp_f32 v37, v37
    v_exp_f32 v38, v38
    v_exp_f32 v39, v39
    v_exp_f32 v8, v8
    v_exp_f32 v9, v9
    v_smfmac_f32_32x32x32_bf16 v[120:135], v[52:55], v[32:39], v5
    ds_read_b128 v[40:43], v153 offset:6144
    v_exp_f32 v10, v10
    v_exp_f32 v11, v11
    v_exp_f32 v12, v12
    v_mfma_f32_32x32x16_bf16 v[24:39], v[44:47], v[68:71], v[88:103]
    ds_read_b128 v[48:51], v156 offset:6144
    v_exp_f32 v13, v13
    v_exp_f32 v14, v14
    v_exp_f32 v15, v15
    v_exp_f32 v16, v16
    v_exp_f32 v17, v17
    v_smfmac_f32_32x32x32_bf16 v[104:119], v[56:59], v[8:15], v5
    ds_read_b128 v[52:55], v156 offset:6656
    v_exp_f32 v18, v18
    v_exp_f32 v19, v19
    v_exp_f32 v20, v20
    v_exp_f32 v21, v21
    v_exp_f32 v22, v22
    v_exp_f32 v23, v23
    v_exp_f32 v24, v24
    v_exp_f32 v25, v25
    v_smfmac_f32_32x32x32_bf16 v[104:119], v[60:63], v[16:23], v5
    buffer_load_dwordx4 v141, s[16:19], s50 offen lds
    v_exp_f32 v26, v26
    v_exp_f32 v27, v27
    v_exp_f32 v28, v28
    s_waitcnt lgkmcnt(0)
    v_mfma_f32_32x32x16_bf16 v[8:23], v[40:43], v[64:67], v[72:87]
    s_add_u32 s50, s50, 65536
    v_exp_f32 v29, v29
    v_exp_f32 v30, v30
    v_exp_f32 v31, v31
    v_exp_f32 v32, v32
    v_exp_f32 v33, v33
    v_smfmac_f32_32x32x32_bf16 v[120:135], v[56:59], v[24:31], v5
    s_add_u32 m0, s57, 49152
    v_exp_f32 v34, v34
    v_exp_f32 v35, v35
    v_exp_f32 v36, v36
    v_exp_f32 v37, v37
    v_exp_f32 v38, v38
    v_exp_f32 v39, v39
    v_exp_f32 v8, v8
    v_exp_f32 v9, v9
    v_smfmac_f32_32x32x32_bf16 v[120:135], v[60:63], v[32:39], v5
    s_setprio 0
    ds_read_b128 v[44:47], v153 offset:7168
    v_exp_f32 v10, v10
    v_exp_f32 v11, v11
    v_exp_f32 v12, v12
    v_mfma_f32_32x32x16_bf16 v[24:39], v[40:43], v[68:71], v[88:103]
    ds_read_b128 v[56:59], v156 offset:7168
    v_exp_f32 v13, v13
    v_exp_f32 v14, v14
    v_exp_f32 v15, v15
    v_exp_f32 v16, v16
    v_exp_f32 v17, v17
    v_smfmac_f32_32x32x32_bf16 v[104:119], v[48:51], v[8:15], v5
    ds_read_b128 v[60:63], v156 offset:7680
    v_exp_f32 v18, v18
    v_exp_f32 v19, v19
    v_exp_f32 v20, v20
    v_exp_f32 v21, v21
    v_exp_f32 v22, v22
    v_exp_f32 v23, v23
    v_exp_f32 v24, v24
    v_exp_f32 v25, v25
    v_smfmac_f32_32x32x32_bf16 v[104:119], v[52:55], v[16:23], v5
    buffer_load_dwordx4 v141, s[16:19], s50 offen lds
    v_exp_f32 v26, v26
    v_exp_f32 v27, v27
    v_exp_f32 v28, v28
    s_waitcnt lgkmcnt(0)
    v_mfma_f32_32x32x16_bf16 v[8:23], v[44:47], v[64:67], v[72:87]
    s_add_u32 s50, s50, 65536
    v_exp_f32 v29, v29
    v_exp_f32 v30, v30
    v_exp_f32 v31, v31
    v_exp_f32 v32, v32
    v_exp_f32 v33, v33
    v_smfmac_f32_32x32x32_bf16 v[120:135], v[48:51], v[24:31], v5
    s_add_u32 m0, s57, 57344
    v_exp_f32 v34, v34
    v_exp_f32 v35, v35
    v_exp_f32 v36, v36
    v_exp_f32 v37, v37
    v_exp_f32 v38, v38
    v_exp_f32 v39, v39
    v_exp_f32 v8, v8
    v_exp_f32 v9, v9
    v_smfmac_f32_32x32x32_bf16 v[120:135], v[52:55], v[32:39], v5
    s_waitcnt vmcnt(7)
    s_barrier
    s_setprio 1
    ds_read_b128 v[40:43], v153 offset:32768
    v_exp_f32 v10, v10
    v_exp_f32 v11, v11
    v_exp_f32 v12, v12
    v_mfma_f32_32x32x16_bf16 v[24:39], v[44:47], v[68:71], v[88:103]
    ds_read_b128 v[48:51], v157 offset:0
    v_exp_f32 v13, v13
    v_exp_f32 v14, v14
    v_exp_f32 v15, v15
    v_exp_f32 v16, v16
    v_exp_f32 v17, v17
    v_smfmac_f32_32x32x32_bf16 v[104:119], v[56:59], v[8:15], v5
    ds_read_b128 v[52:55], v157 offset:512
    v_exp_f32 v18, v18
    v_exp_f32 v19, v19
    v_exp_f32 v20, v20
    v_exp_f32 v21, v21
    v_exp_f32 v22, v22
    v_exp_f32 v23, v23
    v_exp_f32 v24, v24
    v_exp_f32 v25, v25
    v_smfmac_f32_32x32x32_bf16 v[104:119], v[60:63], v[16:23], v5
    buffer_load_dwordx4 v141, s[16:19], s50 offen lds
    v_exp_f32 v26, v26
    v_exp_f32 v27, v27
    v_exp_f32 v28, v28
    s_waitcnt lgkmcnt(0)
    v_mfma_f32_32x32x16_bf16 v[8:23], v[40:43], v[64:67], v[72:87]
    v_exp_f32 v29, v29
    v_exp_f32 v30, v30
    v_exp_f32 v31, v31
    v_exp_f32 v32, v32
    v_exp_f32 v33, v33
    v_smfmac_f32_32x32x32_bf16 v[120:135], v[56:59], v[24:31], v5
    v_exp_f32 v34, v34
    v_exp_f32 v35, v35
    v_exp_f32 v36, v36
    v_exp_f32 v37, v37
    v_exp_f32 v38, v38
    v_exp_f32 v39, v39
    v_exp_f32 v8, v8
    v_exp_f32 v9, v9
    v_smfmac_f32_32x32x32_bf16 v[120:135], v[60:63], v[32:39], v5
    ds_read_b128 v[44:47], v153 offset:33792
    v_exp_f32 v10, v10
    v_exp_f32 v11, v11
    v_exp_f32 v12, v12
    v_mfma_f32_32x32x16_bf16 v[24:39], v[40:43], v[68:71], v[88:103]
    ds_read_b128 v[56:59], v157 offset:1024
    v_exp_f32 v13, v13
    v_exp_f32 v14, v14
    v_exp_f32 v15, v15
    v_exp_f32 v16, v16
    v_exp_f32 v17, v17
    v_smfmac_f32_32x32x32_bf16 v[104:119], v[48:51], v[8:15], v5
    ds_read_b128 v[60:63], v157 offset:1536
    v_exp_f32 v18, v18
    v_exp_f32 v19, v19
    v_exp_f32 v20, v20
    v_exp_f32 v21, v21
    v_exp_f32 v22, v22
    v_exp_f32 v23, v23
    v_exp_f32 v24, v24
    v_exp_f32 v25, v25
    v_smfmac_f32_32x32x32_bf16 v[104:119], v[52:55], v[16:23], v5
    v_exp_f32 v26, v26
    v_exp_f32 v27, v27
    v_exp_f32 v28, v28
    s_waitcnt lgkmcnt(0)
    v_mfma_f32_32x32x16_bf16 v[8:23], v[44:47], v[64:67], v[72:87]
    v_exp_f32 v29, v29
    v_exp_f32 v30, v30
    v_exp_f32 v31, v31
    v_exp_f32 v32, v32
    v_exp_f32 v33, v33
    v_smfmac_f32_32x32x32_bf16 v[120:135], v[48:51], v[24:31], v5
    v_exp_f32 v34, v34
    v_exp_f32 v35, v35
    v_exp_f32 v36, v36
    v_exp_f32 v37, v37
    v_exp_f32 v38, v38
    v_exp_f32 v39, v39
    v_exp_f32 v8, v8
    v_exp_f32 v9, v9
    v_smfmac_f32_32x32x32_bf16 v[120:135], v[52:55], v[32:39], v5
    ds_read_b128 v[40:43], v153 offset:34816
    v_exp_f32 v10, v10
    v_exp_f32 v11, v11
    v_exp_f32 v12, v12
    v_mfma_f32_32x32x16_bf16 v[24:39], v[44:47], v[68:71], v[88:103]
    ds_read_b128 v[48:51], v157 offset:2048
    v_exp_f32 v13, v13
    v_exp_f32 v14, v14
    v_exp_f32 v15, v15
    v_exp_f32 v16, v16
    v_exp_f32 v17, v17
    v_smfmac_f32_32x32x32_bf16 v[104:119], v[56:59], v[8:15], v5
    ds_read_b128 v[52:55], v157 offset:2560
    v_exp_f32 v18, v18
    v_exp_f32 v19, v19
    v_exp_f32 v20, v20
    v_exp_f32 v21, v21
    v_exp_f32 v22, v22
    v_exp_f32 v23, v23
    v_exp_f32 v24, v24
    v_exp_f32 v25, v25
    v_smfmac_f32_32x32x32_bf16 v[104:119], v[60:63], v[16:23], v5
    v_exp_f32 v26, v26
    v_exp_f32 v27, v27
    v_exp_f32 v28, v28
    s_waitcnt lgkmcnt(0)
    v_mfma_f32_32x32x16_bf16 v[8:23], v[40:43], v[64:67], v[72:87]
    v_exp_f32 v29, v29
    v_exp_f32 v30, v30
    v_exp_f32 v31, v31
    v_exp_f32 v32, v32
    v_exp_f32 v33, v33
    v_smfmac_f32_32x32x32_bf16 v[120:135], v[56:59], v[24:31], v5
    v_exp_f32 v34, v34
    v_exp_f32 v35, v35
    v_exp_f32 v36, v36
    v_exp_f32 v37, v37
    v_exp_f32 v38, v38
    v_exp_f32 v39, v39
    v_exp_f32 v8, v8
    v_exp_f32 v9, v9
    v_smfmac_f32_32x32x32_bf16 v[120:135], v[60:63], v[32:39], v5
    ds_read_b128 v[44:47], v153 offset:35840
    v_exp_f32 v10, v10
    v_exp_f32 v11, v11
    v_exp_f32 v12, v12
    v_mfma_f32_32x32x16_bf16 v[24:39], v[40:43], v[68:71], v[88:103]
    ds_read_b128 v[56:59], v157 offset:3072
    v_exp_f32 v13, v13
    v_exp_f32 v14, v14
    v_exp_f32 v15, v15
    v_exp_f32 v16, v16
    v_exp_f32 v17, v17
    v_smfmac_f32_32x32x32_bf16 v[104:119], v[48:51], v[8:15], v5
    ds_read_b128 v[60:63], v157 offset:3584
    v_exp_f32 v18, v18
    v_exp_f32 v19, v19
    v_exp_f32 v20, v20
    v_exp_f32 v21, v21
    v_exp_f32 v22, v22
    v_exp_f32 v23, v23
    v_exp_f32 v24, v24
    v_exp_f32 v25, v25
    v_smfmac_f32_32x32x32_bf16 v[104:119], v[52:55], v[16:23], v5
    v_exp_f32 v26, v26
    v_exp_f32 v27, v27
    v_exp_f32 v28, v28
    s_waitcnt lgkmcnt(0)
    v_mfma_f32_32x32x16_bf16 v[8:23], v[44:47], v[64:67], v[72:87]
    v_exp_f32 v29, v29
    v_exp_f32 v30, v30
    v_exp_f32 v31, v31
    v_exp_f32 v32, v32
    v_exp_f32 v33, v33
    v_smfmac_f32_32x32x32_bf16 v[120:135], v[48:51], v[24:31], v5
    v_exp_f32 v34, v34
    v_exp_f32 v35, v35
    v_exp_f32 v36, v36
    v_exp_f32 v37, v37
    v_exp_f32 v38, v38
    v_exp_f32 v39, v39
    v_exp_f32 v8, v8
    v_exp_f32 v9, v9
    v_smfmac_f32_32x32x32_bf16 v[120:135], v[52:55], v[32:39], v5
    ds_read_b128 v[40:43], v153 offset:36864
    v_exp_f32 v10, v10
    v_exp_f32 v11, v11
    v_exp_f32 v12, v12
    v_mfma_f32_32x32x16_bf16 v[24:39], v[44:47], v[68:71], v[88:103]
    ds_read_b128 v[48:51], v157 offset:4096
    v_exp_f32 v13, v13
    v_exp_f32 v14, v14
    v_exp_f32 v15, v15
    v_exp_f32 v16, v16
    v_exp_f32 v17, v17
    v_smfmac_f32_32x32x32_bf16 v[104:119], v[56:59], v[8:15], v5
    ds_read_b128 v[52:55], v157 offset:4608
    v_exp_f32 v18, v18
    v_exp_f32 v19, v19
    v_exp_f32 v20, v20
    v_exp_f32 v21, v21
    v_exp_f32 v22, v22
    v_exp_f32 v23, v23
    v_exp_f32 v24, v24
    v_exp_f32 v25, v25
    v_smfmac_f32_32x32x32_bf16 v[104:119], v[60:63], v[16:23], v5
    v_exp_f32 v26, v26
    v_exp_f32 v27, v27
    v_exp_f32 v28, v28
    s_waitcnt lgkmcnt(0)
    v_mfma_f32_32x32x16_bf16 v[8:23], v[40:43], v[64:67], v[72:87]
    v_exp_f32 v29, v29
    v_exp_f32 v30, v30
    v_exp_f32 v31, v31
    v_exp_f32 v32, v32
    v_exp_f32 v33, v33
    v_smfmac_f32_32x32x32_bf16 v[120:135], v[56:59], v[24:31], v5
    v_exp_f32 v34, v34
    v_exp_f32 v35, v35
    v_exp_f32 v36, v36
    v_exp_f32 v37, v37
    v_exp_f32 v38, v38
    v_exp_f32 v39, v39
    v_exp_f32 v8, v8
    v_exp_f32 v9, v9
    v_smfmac_f32_32x32x32_bf16 v[120:135], v[60:63], v[32:39], v5
    ds_read_b128 v[44:47], v153 offset:37888
    v_exp_f32 v10, v10
    v_exp_f32 v11, v11
    v_exp_f32 v12, v12
    v_mfma_f32_32x32x16_bf16 v[24:39], v[40:43], v[68:71], v[88:103]
    ds_read_b128 v[56:59], v157 offset:5120
    v_exp_f32 v13, v13
    v_exp_f32 v14, v14
    v_exp_f32 v15, v15
    v_exp_f32 v16, v16
    v_exp_f32 v17, v17
    v_smfmac_f32_32x32x32_bf16 v[104:119], v[48:51], v[8:15], v5
    ds_read_b128 v[60:63], v157 offset:5632
    v_exp_f32 v18, v18
    v_exp_f32 v19, v19
    v_exp_f32 v20, v20
    v_exp_f32 v21, v21
    v_exp_f32 v22, v22
    v_exp_f32 v23, v23
    v_exp_f32 v24, v24
    v_exp_f32 v25, v25
    v_smfmac_f32_32x32x32_bf16 v[104:119], v[52:55], v[16:23], v5
    v_exp_f32 v26, v26
    v_exp_f32 v27, v27
    v_exp_f32 v28, v28
    s_waitcnt lgkmcnt(0)
    v_mfma_f32_32x32x16_bf16 v[8:23], v[44:47], v[64:67], v[72:87]
    v_exp_f32 v29, v29
    v_exp_f32 v30, v30
    v_exp_f32 v31, v31
    v_exp_f32 v32, v32
    v_exp_f32 v33, v33
    v_smfmac_f32_32x32x32_bf16 v[120:135], v[48:51], v[24:31], v5
    v_exp_f32 v34, v34
    v_exp_f32 v35, v35
    v_exp_f32 v36, v36
    v_exp_f32 v37, v37
    v_exp_f32 v38, v38
    v_exp_f32 v39, v39
    v_exp_f32 v8, v8
    v_exp_f32 v9, v9
    v_smfmac_f32_32x32x32_bf16 v[120:135], v[52:55], v[32:39], v5
    ds_read_b128 v[40:43], v153 offset:38912
    v_exp_f32 v10, v10
    v_exp_f32 v11, v11
    v_exp_f32 v12, v12
    v_mfma_f32_32x32x16_bf16 v[24:39], v[44:47], v[68:71], v[88:103]
    ds_read_b128 v[48:51], v157 offset:6144
    v_exp_f32 v13, v13
    v_exp_f32 v14, v14
    v_exp_f32 v15, v15
    v_exp_f32 v16, v16
    v_exp_f32 v17, v17
    v_smfmac_f32_32x32x32_bf16 v[104:119], v[56:59], v[8:15], v5
    ds_read_b128 v[52:55], v157 offset:6656
    v_exp_f32 v18, v18
    v_exp_f32 v19, v19
    v_exp_f32 v20, v20
    v_exp_f32 v21, v21
    v_exp_f32 v22, v22
    v_exp_f32 v23, v23
    v_exp_f32 v24, v24
    v_exp_f32 v25, v25
    v_smfmac_f32_32x32x32_bf16 v[104:119], v[60:63], v[16:23], v5
    v_exp_f32 v26, v26
    v_exp_f32 v27, v27
    v_exp_f32 v28, v28
    s_waitcnt lgkmcnt(0)
    v_mfma_f32_32x32x16_bf16 v[8:23], v[40:43], v[64:67], v[72:87]
    v_exp_f32 v29, v29
    v_exp_f32 v30, v30
    v_exp_f32 v31, v31
    v_exp_f32 v32, v32
    v_exp_f32 v33, v33
    v_smfmac_f32_32x32x32_bf16 v[120:135], v[56:59], v[24:31], v5
    v_exp_f32 v34, v34
    v_exp_f32 v35, v35
    v_exp_f32 v36, v36
    v_exp_f32 v37, v37
    v_exp_f32 v38, v38
    v_exp_f32 v39, v39
    v_exp_f32 v8, v8
    v_exp_f32 v9, v9
    v_smfmac_f32_32x32x32_bf16 v[120:135], v[60:63], v[32:39], v5
    s_setprio 0
    ds_read_b128 v[44:47], v153 offset:39936
    v_exp_f32 v10, v10
    v_exp_f32 v11, v11
    v_exp_f32 v12, v12
    v_mfma_f32_32x32x16_bf16 v[24:39], v[40:43], v[68:71], v[88:103]
    ds_read_b128 v[56:59], v157 offset:7168
    v_exp_f32 v13, v13
    v_exp_f32 v14, v14
    v_exp_f32 v15, v15
    v_exp_f32 v16, v16
    v_exp_f32 v17, v17
    v_smfmac_f32_32x32x32_bf16 v[104:119], v[48:51], v[8:15], v5
    ds_read_b128 v[60:63], v157 offset:7680
    v_exp_f32 v18, v18
    v_exp_f32 v19, v19
    v_exp_f32 v20, v20
    v_exp_f32 v21, v21
    v_exp_f32 v22, v22
    v_exp_f32 v23, v23
    v_exp_f32 v24, v24
    v_exp_f32 v25, v25
    v_smfmac_f32_32x32x32_bf16 v[104:119], v[52:55], v[16:23], v5
    v_exp_f32 v26, v26
    v_exp_f32 v27, v27
    v_exp_f32 v28, v28
    s_waitcnt lgkmcnt(0)
    v_mfma_f32_32x32x16_bf16 v[8:23], v[44:47], v[64:67], v[72:87]
    v_exp_f32 v29, v29
    v_exp_f32 v30, v30
    v_exp_f32 v31, v31
    v_exp_f32 v32, v32
    v_exp_f32 v33, v33
    v_smfmac_f32_32x32x32_bf16 v[120:135], v[48:51], v[24:31], v5
    v_exp_f32 v34, v34
    v_exp_f32 v35, v35
    v_exp_f32 v36, v36
    v_exp_f32 v37, v37
    v_exp_f32 v38, v38
    v_exp_f32 v39, v39
    v_exp_f32 v8, v8
    v_exp_f32 v9, v9
    v_smfmac_f32_32x32x32_bf16 v[120:135], v[52:55], v[32:39], v5
    buffer_load_dword v139, v148, s[8:11], s59 offen sc1
    v_exp_f32 v10, v10
    v_exp_f32 v11, v11
    v_exp_f32 v12, v12
    v_mfma_f32_32x32x16_bf16 v[24:39], v[44:47], v[68:71], v[88:103]
    v_exp_f32 v13, v13
    v_exp_f32 v14, v14
    v_exp_f32 v15, v15
    v_exp_f32 v16, v16
    v_exp_f32 v17, v17
    v_smfmac_f32_32x32x32_bf16 v[104:119], v[56:59], v[8:15], v5
    v_exp_f32 v18, v18
    v_exp_f32 v19, v19
    v_exp_f32 v20, v20
    v_exp_f32 v21, v21
    v_exp_f32 v22, v22
    v_exp_f32 v23, v23
    v_exp_f32 v24, v24
    v_exp_f32 v25, v25
    v_smfmac_f32_32x32x32_bf16 v[104:119], v[60:63], v[16:23], v5
    v_exp_f32 v26, v26
    v_exp_f32 v27, v27
    v_exp_f32 v28, v28
    v_exp_f32 v29, v29
    v_exp_f32 v30, v30
    v_exp_f32 v31, v31
    v_exp_f32 v32, v32
    v_exp_f32 v33, v33
    v_smfmac_f32_32x32x32_bf16 v[120:135], v[56:59], v[24:31], v5
    v_exp_f32 v34, v34
    v_exp_f32 v35, v35
    v_exp_f32 v36, v36
    v_exp_f32 v37, v37
    v_exp_f32 v38, v38
    v_exp_f32 v39, v39
    s_setprio 0
    v_rcp_f32 v114, v112
    s_nop 0
    v_smfmac_f32_32x32x32_bf16 v[120:135], v[60:63], v[32:39], v5
    v_mov_b32 v8, 0
    v_mov_b32 v9, 0
    v_mul_f32 v113, s51, v112
    v_pk_fma_f32 v[8:9], v[104:105], 0, v[8:9] op_sel_hi:[1,0,1]
    v_pk_fma_f32 v[8:9], v[106:107], 0, v[8:9] op_sel_hi:[1,0,1]
    v_pk_fma_f32 v[8:9], v[108:109], 0, v[8:9] op_sel_hi:[1,0,1]
    v_pk_fma_f32 v[8:9], v[110:111], 0, v[8:9] op_sel_hi:[1,0,1]
    v_pk_fma_f32 v[8:9], v[112:113], 0, v[8:9] op_sel_hi:[1,0,1]
    s_nop 3
    v_rcp_f32 v130, v128
    v_mul_f32 v129, s51, v128
    v_pk_fma_f32 v[8:9], v[120:121], 0, v[8:9] op_sel_hi:[1,0,1]
    v_pk_fma_f32 v[8:9], v[122:123], 0, v[8:9] op_sel_hi:[1,0,1]
    v_pk_fma_f32 v[8:9], v[124:125], 0, v[8:9] op_sel_hi:[1,0,1]
    v_pk_fma_f32 v[8:9], v[126:127], 0, v[8:9] op_sel_hi:[1,0,1]
    v_pk_fma_f32 v[8:9], v[128:129], 0, v[8:9] op_sel_hi:[1,0,1]
    v_cmp_u_f32 vcc, v8, v9
    s_cbranch_vccnz L_slow
L_attn_store:
    v_mul_f32 v104, v114, v104
    v_mul_f32 v105, v114, v105
    v_mul_f32 v106, v114, v106
    v_mul_f32 v107, v114, v107
    v_mul_f32 v108, v114, v108
    v_mul_f32 v109, v114, v109
    v_mul_f32 v110, v114, v110
    v_mul_f32 v111, v114, v111
    v_cvt_pk_bf16_f32 v116, v104, v105
    v_cvt_pk_bf16_f32 v117, v106, v107
    v_cvt_pk_bf16_f32 v118, v108, v109
    v_cvt_pk_bf16_f32 v119, v110, v111
    buffer_store_dwordx4 v[116:119], v2, s[8:11], s55 offen sc1
    v_mul_f32 v120, v130, v120
    v_mul_f32 v121, v130, v121
    v_mul_f32 v122, v130, v122
    v_mul_f32 v123, v130, v123
    v_mul_f32 v124, v130, v124
    v_mul_f32 v125, v130, v125
    v_mul_f32 v126, v130, v126
    v_mul_f32 v127, v130, v127
    v_cvt_pk_bf16_f32 v132, v120, v121
    v_cvt_pk_bf16_f32 v133, v122, v123
    v_cvt_pk_bf16_f32 v134, v124, v125
    v_cvt_pk_bf16_f32 v135, v126, v127
    s_add_u32 s55, s55, 32768
    buffer_store_dwordx4 v[132:135], v2, s[8:11], s55 offen sc1
    s_cmp_lg_u32 s3, 5
    s_cbranch_scc1 L_not5
    s_mov_b32 s38, 0x40000
    s_waitcnt vmcnt(2)
    v_cmp_eq_u32 vcc, s7, v139
    s_nop 0
    s_and_b32 s39, vcc_lo, 0xffff
    v_mov_b32 v139, s39
    ds_write_b32 v140, v139
    s_waitcnt vmcnt(0) lgkmcnt(0)
    s_barrier
L_poll2:
    buffer_load_dword v8, v148, s[8:11], s59 offen sc1
    s_waitcnt vmcnt(0)
    v_cmp_eq_u32 vcc, s7, v8
    s_sub_u32 s38, s38, 1
    s_cselect_b32 s39, -1, vcc_lo
    s_and_b32 s39, s39, 0xffff
    v_mov_b32 v139, s39
    ds_write_b32 v140, v139
    s_cmp_eq_u32 s39, 0xffff
    s_cbranch_scc1 L_poll2_x
    s_sleep 2
    s_branch L_poll2
L_poll2_x:
    s_branch L_end
L_not5:
    s_waitcnt vmcnt(0)
    s_barrier
    s_cmp_lt_u32 s3, 4
    s_cbranch_scc1 L_proj
    s_cmp_lg_u32 s3, 4
    s_cbranch_scc1 L_end
    v_mov_b32 v136, s7
    v_lshlrev_b32 v137, 11, v1
    s_mov_b64 exec, 3
    buffer_store_dword v136, v137, s[8:11], s22 offen sc1
    s_mov_b64 exec, -1
    s_branch L_end
L_proj:
    s_mov_b32 s48, 0
    s_mov_b32 s49, 0
    s_mov_b32 s50, 0x400000
    s_lshl_b32 s51, s47, 1
    s_cmp_eq_u32 s48, 0
    s_cbranch_scc1 L_pw0
L_pk0:
    s_ff1_i32_b32 s38, s48
    s_bitset0_b32 s48, s38
    s_bitset1_b32 s49, s38
    s_add_u32 s38, s38, s51
    s_and_b32 s38, s38, 15
    s_lshl_b32 s52, s38, 11
    s_add_u32 s39, s20, s52
    buffer_load_dwordx4 v[72:75], v2, s[8:11], s39 offen offset:0 sc1
    buffer_load_dwordx4 v[76:79], v2, s[8:11], s39 offen offset:1024 sc1
    v_lshl_add_u32 v4, s52, 1, v142
    v_lshl_add_u32 v5, s52, 1, v143
    ds_read_b64_tr_b16 v[8:9], v4 offset:0
    ds_read_b64_tr_b16 v[10:11], v4 offset:1024
    ds_read_b64_tr_b16 v[12:13], v5 offset:0
    ds_read_b64_tr_b16 v[14:15], v5 offset:1024
    ds_read_b64_tr_b16 v[16:17], v4 offset:2048
    ds_read_b64_tr_b16 v[18:19], v4 offset:3072
    ds_read_b64_tr_b16 v[20:21], v5 offset:2048
    ds_read_b64_tr_b16 v[22:23], v5 offset:3072
    s_cmp_eq_u32 s48, 0
    s_cbranch_scc1 L_pw1
L_pk1:
    s_ff1_i32_b32 s38, s48
    s_bitset0_b32 s48, s38
    s_bitset1_b32 s49, s38
    s_add_u32 s38, s38, s51
    s_and_b32 s38, s38, 15
    s_lshl_b32 s53, s38, 11
    s_add_u32 s39, s20, s53
    buffer_load_dwordx4 v[80:83], v2, s[8:11], s39 offen offset:0 sc1
    buffer_load_dwordx4 v[84:87], v2, s[8:11], s39 offen offset:1024 sc1
    v_lshl_add_u32 v6, s53, 1, v142
    v_lshl_add_u32 v7, s53, 1, v143
    s_cmp_eq_u32 s48, 0
    s_cbranch_scc1 L_pw2
L_pk2:
    s_ff1_i32_b32 s38, s48
    s_bitset0_b32 s48, s38
    s_bitset1_b32 s49, s38
    s_add_u32 s38, s38, s51
    s_and_b32 s38, s38, 15
    s_lshl_b32 s54, s38, 11
    s_add_u32 s39, s20, s54
    buffer_load_dwordx4 v[88:91], v2, s[8:11], s39 offen offset:0 sc1
    buffer_load_dwordx4 v[92:95], v2, s[8:11], s39 offen offset:1024 sc1
    s_cmp_eq_u32 s48, 0
    s_cbranch_scc1 L_pw3
L_pk3:
    s_ff1_i32_b32 s38, s48
    s_bitset0_b32 s48, s38
    s_bitset1_b32 s49, s38
    s_add_u32 s38, s38, s51
    s_and_b32 s38, s38, 15
    s_lshl_b32 s55, s38, 11
    s_add_u32 s39, s20, s55
    buffer_load_dwordx4 v[96:99], v2, s[8:11], s39 offen offset:0 sc1
    buffer_load_dwordx4 v[100:103], v2, s[8:11], s39 offen offset:1024 sc1
    s_cmp_eq_u32 s48, 0
    s_cbranch_scc1 L_pw4
L_pk4:
    s_ff1_i32_b32 s38, s48
    s_bitset0_b32 s48, s38
    s_bitset1_b32 s49, s38
    s_add_u32 s38, s38, s51
    s_and_b32 s38, s38, 15
    s_lshl_b32 s56, s38, 11
    s_add_u32 s39, s20, s56
    buffer_load_dwordx4 v[104:107], v2, s[8:11], s39 offen offset:0 sc1
    buffer_load_dwordx4 v[108:111], v2, s[8:11], s39 offen offset:1024 sc1
    s_cmp_eq_u32 s48, 0
    s_cbranch_scc1 L_pw5
L_pk5:
    s_ff1_i32_b32 s38, s48
    s_bitset0_b32 s48, s38
    s_bitset1_b32 s49, s38
    s_add_u32 s38, s38, s51
    s_and_b32 s38, s38, 15
    s_lshl_b32 s57, s38, 11
    s_add_u32 s39, s20, s57
    buffer_load_dwordx4 v[112:115], v2, s[8:11], s39 offen offset:0 sc1
    buffer_load_dwordx4 v[116:119], v2, s[8:11], s39 offen offset:1024 sc1
    s_mov_b32 s12, s36
    s_mov_b32 s13, s37
    s_mov_b32 s14, 4194304
    s_mov_b32 s15, 0x20000
    s_waitcnt vmcnt(10) lgkmcnt(0)
    v_mfma_f32_32x32x16_bf16 v[40:55], v[8:11], v[72:75], 0
    ds_read_b64_tr_b16 v[24:25], v6 offset:0
    ds_read_b64_tr_b16 v[26:27], v6 offset:1024
    ds_read_b64_tr_b16 v[28:29], v7 offset:0
    ds_read_b64_tr_b16 v[30:31], v7 offset:1024
    v_mfma_f32_32x32x16_bf16 v[56:71], v[12:15], v[72:75], 0
    ds_read_b64_tr_b16 v[32:33], v6 offset:2048
    ds_read_b64_tr_b16 v[34:35], v6 offset:3072
    ds_read_b64_tr_b16 v[36:37], v7 offset:2048
    ds_read_b64_tr_b16 v[38:39], v7 offset:3072
    v_mfma_f32_32x32x16_bf16 v[40:55], v[16:19], v[76:79], v[40:55]
    v_lshl_add_u32 v4, s54, 1, v142
    v_lshl_add_u32 v5, s54, 1, v143
    s_cmp_eq_u32 s48, 0
    s_cbranch_scc1 L_pw6
L_pk6:
    s_ff1_i32_b32 s38, s48
    s_bitset0_b32 s48, s38
    s_bitset1_b32 s49, s38
    s_add_u32 s38, s38, s51
    s_and_b32 s38, s38, 15
    s_lshl_b32 s58, s38, 11
    s_add_u32 s39, s20, s58
    v_mfma_f32_32x32x16_bf16 v[56:71], v[20:23], v[76:79], v[56:71]
    buffer_load_dwordx4 v[120:123], v2, s[8:11], s39 offen offset:0 sc1
    buffer_load_dwordx4 v[124:127], v2, s[8:11], s39 offen offset:1024 sc1
    s_waitcnt vmcnt(10) lgkmcnt(0)
    v_mfma_f32_32x32x16_bf16 v[40:55], v[24:27], v[80:83], v[40:55]
    ds_read_b64_tr_b16 v[8:9], v4 offset:0
    ds_read_b64_tr_b16 v[10:11], v4 offset:1024
    ds_read_b64_tr_b16 v[12:13], v5 offset:0
    ds_read_b64_tr_b16 v[14:15], v5 offset:1024
    v_mfma_f32_32x32x16_bf16 v[56:71], v[28:31], v[80:83], v[56:71]
    ds_read_b64_tr_b16 v[16:17], v4 offset:2048
    ds_read_b64_tr_b16 v[18:19], v4 offset:3072
    ds_read_b64_tr_b16 v[20:21], v5 offset:2048
    ds_read_b64_tr_b16 v[22:23], v5 offset:3072
    v_mfma_f32_32x32x16_bf16 v[40:55], v[32:35], v[84:87], v[40:55]
    v_lshl_add_u32 v6, s55, 1, v142
    v_lshl_add_u32 v7, s55, 1, v143
    s_cmp_eq_u32 s48, 0
    s_cbranch_scc1 L_pw7
L_pk7:
    s_ff1_i32_b32 s38, s48
    s_bitset0_b32 s48, s38
    s_bitset1_b32 s49, s38
    s_add_u32 s38, s38, s51
    s_and_b32 s38, s38, 15
    s_lshl_b32 s59, s38, 11
    s_add_u32 s39, s20, s59
    v_mfma_f32_32x32x16_bf16 v[56:71], v[36:39], v[84:87], v[56:71]
    buffer_load_dwordx4 v[128:131], v2, s[8:11], s39 offen offset:0 sc1
    buffer_load_dwordx4 v[132:135], v2, s[8:11], s39 offen offset:1024 sc1
    s_waitcnt vmcnt(10) lgkmcnt(0)
    v_mfma_f32_32x32x16_bf16 v[40:55], v[8:11], v[88:91], v[40:55]
    ds_read_b64_tr_b16 v[24:25], v6 offset:0
    ds_read_b64_tr_b16 v[26:27], v6 offset:1024
    ds_read_b64_tr_b16 v[28:29], v7 offset:0
    ds_read_b64_tr_b16 v[30:31], v7 offset:1024
    v_mfma_f32_32x32x16_bf16 v[56:71], v[12:15], v[88:91], v[56:71]
    ds_read_b64_tr_b16 v[32:33], v6 offset:2048
    ds_read_b64_tr_b16 v[34:35], v6 offset:3072
    ds_read_b64_tr_b16 v[36:37], v7 offset:2048
    ds_read_b64_tr_b16 v[38:39], v7 offset:3072
    v_mfma_f32_32x32x16_bf16 v[40:55], v[16:19], v[92:95], v[40:55]
    v_lshl_add_u32 v4, s56, 1, v142
    v_lshl_add_u32 v5, s56, 1, v143
    s_cmp_eq_u32 s48, 0
    s_cbranch_scc1 L_pw8
L_pk8:
    s_ff1_i32_b32 s38, s48
    s_bitset0_b32 s48, s38
    s_bitset1_b32 s49, s38
    s_add_u32 s38, s38, s51
    s_and_b32 s38, s38, 15
    s_lshl_b32 s52, s38, 11
    s_add_u32 s39, s20, s52
    v_mfma_f32_32x32x16_bf16 v[56:71], v[20:23], v[92:95], v[56:71]
    buffer_load_dwordx4 v[160:163], v2, s[8:11], s39 offen offset:0 sc1
    buffer_load_dwordx4 v[164:167], v2, s[8:11], s39 offen offset:1024 sc1
    s_waitcnt vmcnt(10) lgkmcnt(0)
    v_mfma_f32_32x32x16_bf16 v[40:55], v[24:27], v[96:99], v[40:55]
    ds_read_b64_tr_b16 v[8:9], v4 offset:0
    ds_read_b64_tr_b16 v[10:11], v4 offset:1024
    ds_read_b64_tr_b16 v[12:13], v5 offset:0
    ds_read_b64_tr_b16 v[14:15], v5 offset:1024
    v_mfma_f32_32x32x16_bf16 v[56:71], v[28:31], v[96:99], v[56:71]
    ds_read_b64_tr_b16 v[16:17], v4 offset:2048
    ds_read_b64_tr_b16 v[18:19], v4 offset:3072
    ds_read_b64_tr_b16 v[20:21], v5 offset:2048
    ds_read_b64_tr_b16 v[22:23], v5 offset:3072
    v_mfma_f32_32x32x16_bf16 v[40:55], v[32:35], v[100:103], v[40:55]
    v_lshl_add_u32 v6, s57, 1, v142
    v_lshl_add_u32 v7, s57, 1, v143
    s_cmp_eq_u32 s48, 0
    s_cbranch_scc1 L_pw9
L_pk9:
    s_ff1_i32_b32 s38, s48
    s_bitset0_b32 s48, s38
    s_bitset1_b32 s49, s38
    s_add_u32 s38, s38, s51
    s_and_b32 s38, s38, 15
    s_lshl_b32 s53, s38, 11
    s_add_u32 s39, s20, s53
    v_mfma_f32_32x32x16_bf16 v[56:71], v[36:39], v[100:103], v[56:71]
    buffer_load_dwordx4 v[168:171], v2, s[8:11], s39 offen offset:0 sc1
    buffer_load_dwordx4 v[172:175], v2, s[8:11], s39 offen offset:1024 sc1
    s_waitcnt vmcnt(10) lgkmcnt(0)
    v_mfma_f32_32x32x16_bf16 v[40:55], v[8:11], v[104:107], v[40:55]
    ds_read_b64_tr_b16 v[24:25], v6 offset:0
    ds_read_b64_tr_b16 v[26:27], v6 offset:1024
    ds_read_b64_tr_b16 v[28:29], v7 offset:0
    ds_read_b64_tr_b16 v[30:31], v7 offset:1024
    v_mfma_f32_32x32x16_bf16 v[56:71], v[12:15], v[104:107], v[56:71]
    ds_read_b64_tr_b16 v[32:33], v6 offset:2048
    ds_read_b64_tr_b16 v[34:35], v6 offset:3072
    ds_read_b64_tr_b16 v[36:37], v7 offset:2048
    ds_read_b64_tr_b16 v[38:39], v7 offset:3072
    v_mfma_f32_32x32x16_bf16 v[40:55], v[16:19], v[108:111], v[40:55]
    v_lshl_add_u32 v4, s58, 1, v142
    v_lshl_add_u32 v5, s58, 1, v143
    s_cmp_eq_u32 s48, 0
    s_cbranch_scc1 L_pw10
L_pk10:
    s_ff1_i32_b32 s38, s48
    s_bitset0_b32 s48, s38
    s_bitset1_b32 s49, s38
    s_add_u32 s38, s38, s51
    s_and_b32 s38, s38, 15
    s_lshl_b32 s54, s38, 11
    s_add_u32 s39, s20, s54
    v_mfma_f32_32x32x16_bf16 v[56:71], v[20:23], v[108:111], v[56:71]
    buffer_load_dwordx4 v[176:179], v2, s[8:11], s39 offen offset:0 sc1
    buffer_load_dwordx4 v[180:183], v2, s[8:11], s39 offen offset:1024 sc1
    s_waitcnt vmcnt(10) lgkmcnt(0)
    v_mfma_f32_32x32x16_bf16 v[40:55], v[24:27], v[112:115], v[40:55]
    ds_read_b64_tr_b16 v[8:9], v4 offset:0
    ds_read_b64_tr_b16 v[10:11], v4 offset:1024
    ds_read_b64_tr_b16 v[12:13], v5 offset:0
    ds_read_b64_tr_b16 v[14:15], v5 offset:1024
    v_mfma_f32_32x32x16_bf16 v[56:71], v[28:31], v[112:115], v[56:71]
    ds_read_b64_tr_b16 v[16:17], v4 offset:2048
    ds_read_b64_tr_b16 v[18:19], v4 offset:3072
    ds_read_b64_tr_b16 v[20:21], v5 offset:2048
    ds_read_b64_tr_b16 v[22:23], v5 offset:3072
    v_mfma_f32_32x32x16_bf16 v[40:55], v[32:35], v[116:119], v[40:55]
    v_lshl_add_u32 v6, s59, 1, v142
    v_lshl_add_u32 v7, s59, 1, v143
    s_cmp_eq_u32 s48, 0
    s_cbranch_scc1 L_pw11
L_pk11:
    s_ff1_i32_b32 s38, s48
    s_bitset0_b32 s48, s38
    s_bitset1_b32 s49, s38
    s_add_u32 s38, s38, s51
    s_and_b32 s38, s38, 15
    s_lshl_b32 s55, s38, 11
    s_add_u32 s39, s20, s55
    v_mfma_f32_32x32x16_bf16 v[56:71], v[36:39], v[116:119], v[56:71]
    buffer_load_dwordx4 v[184:187], v2, s[8:11], s39 offen offset:0 sc1
    buffer_load_dwordx4 v[188:191], v2, s[8:11], s39 offen offset:1024 sc1
    s_waitcnt vmcnt(10) lgkmcnt(0)
    v_mfma_f32_32x32x16_bf16 v[40:55], v[8:11], v[120:123], v[40:55]
    ds_read_b64_tr_b16 v[24:25], v6 offset:0
    ds_read_b64_tr_b16 v[26:27], v6 offset:1024
    ds_read_b64_tr_b16 v[28:29], v7 offset:0
    ds_read_b64_tr_b16 v[30:31], v7 offset:1024
    v_mfma_f32_32x32x16_bf16 v[56:71], v[12:15], v[120:123], v[56:71]
    ds_read_b64_tr_b16 v[32:33], v6 offset:2048
    ds_read_b64_tr_b16 v[34:35], v6 offset:3072
    ds_read_b64_tr_b16 v[36:37], v7 offset:2048
    ds_read_b64_tr_b16 v[38:39], v7 offset:3072
    v_mfma_f32_32x32x16_bf16 v[40:55], v[16:19], v[124:127], v[40:55]
    v_lshl_add_u32 v4, s52, 1, v142
    v_lshl_add_u32 v5, s52, 1, v143
    s_cmp_eq_u32 s48, 0
    s_cbranch_scc1 L_pw12
L_pk12:
    s_ff1_i32_b32 s38, s48
    s_bitset0_b32 s48, s38
    s_bitset1_b32 s49, s38
    s_add_u32 s38, s38, s51
    s_and_b32 s38, s38, 15
    s_lshl_b32 s56, s38, 11
    s_add_u32 s39, s20, s56
    v_mfma_f32_32x32x16_bf16 v[56:71], v[20:23], v[124:127], v[56:71]
    buffer_load_dwordx4 v[192:195], v2, s[8:11], s39 offen offset:0 sc1
    buffer_load_dwordx4 v[196:199], v2, s[8:11], s39 offen offset:1024 sc1
    s_waitcnt vmcnt(10) lgkmcnt(0)
    v_mfma_f32_32x32x16_bf16 v[40:55], v[24:27], v[128:131], v[40:55]
    ds_read_b64_tr_b16 v[8:9], v4 offset:0
    ds_read_b64_tr_b16 v[10:11], v4 offset:1024
    ds_read_b64_tr_b16 v[12:13], v5 offset:0
    ds_read_b64_tr_b16 v[14:15], v5 offset:1024
    v_mfma_f32_32x32x16_bf16 v[56:71], v[28:31], v[128:131], v[56:71]
    ds_read_b64_tr_b16 v[16:17], v4 offset:2048
    ds_read_b64_tr_b16 v[18:19], v4 offset:3072
    ds_read_b64_tr_b16 v[20:21], v5 offset:2048
    ds_read_b64_tr_b16 v[22:23], v5 offset:3072
    v_mfma_f32_32x32x16_bf16 v[40:55], v[32:35], v[132:135], v[40:55]
    v_lshl_add_u32 v6, s53, 1, v142
    v_lshl_add_u32 v7, s53, 1, v143
    s_cmp_eq_u32 s48, 0
    s_cbranch_scc1 L_pw13
L_pk13:
    s_ff1_i32_b32 s38, s48
    s_bitset0_b32 s48, s38
    s_bitset1_b32 s49, s38
    s_add_u32 s38, s38, s51
    s_and_b32 s38, s38, 15
    s_lshl_b32 s57, s38, 11
    s_add_u32 s39, s20, s57
    v_mfma_f32_32x32x16_bf16 v[56:71], v[36:39], v[132:135], v[56:71]
    buffer_load_dwordx4 v[200:203], v2, s[8:11], s39 offen offset:0 sc1
    buffer_load_dwordx4 v[204:207], v2, s[8:11], s39 offen offset:1024 sc1
    s_waitcnt vmcnt(10) lgkmcnt(0)
    v_mfma_f32_32x32x16_bf16 v[40:55], v[8:11], v[160:163], v[40:55]
    ds_read_b64_tr_b16 v[24:25], v6 offset:0
    ds_read_b64_tr_b16 v[26:27], v6 offset:1024
    ds_read_b64_tr_b16 v[28:29], v7 offset:0
    ds_read_b64_tr_b16 v[30:31], v7 offset:1024
    v_mfma_f32_32x32x16_bf16 v[56:71], v[12:15], v[160:163], v[56:71]
    ds_read_b64_tr_b16 v[32:33], v6 offset:2048
    ds_read_b64_tr_b16 v[34:35], v6 offset:3072
    ds_read_b64_tr_b16 v[36:37], v7 offset:2048
    ds_read_b64_tr_b16 v[38:39], v7 offset:3072
    v_mfma_f32_32x32x16_bf16 v[40:55], v[16:19], v[164:167], v[40:55]
    v_lshl_add_u32 v4, s54, 1, v142
    v_lshl_add_u32 v5, s54, 1, v143
    s_cmp_eq_u32 s48, 0
    s_cbranch_scc1 L_pw14
L_pk14:
    s_ff1_i32_b32 s38, s48
    s_bitset0_b32 s48, s38
    s_bitset1_b32 s49, s38
    s_add_u32 s38, s38, s51
    s_and_b32 s38, s38, 15
    s_lshl_b32 s58, s38, 11
    s_add_u32 s39, s20, s58
    v_mfma_f32_32x32x16_bf16 v[56:71], v[20:23], v[164:167], v[56:71]
    buffer_load_dwordx4 v[208:211], v2, s[8:11], s39 offen offset:0 sc1
    buffer_load_dwordx4 v[212:215], v2, s[8:11], s39 offen offset:1024 sc1
    s_waitcnt vmcnt(10) lgkmcnt(0)
    v_mfma_f32_32x32x16_bf16 v[40:55], v[24:27], v[168:171], v[40:55]
    ds_read_b64_tr_b16 v[8:9], v4 offset:0
    ds_read_b64_tr_b16 v[10:11], v4 offset:1024
    ds_read_b64_tr_b16 v[12:13], v5 offset:0
    ds_read_b64_tr_b16 v[14:15], v5 offset:1024
    v_mfma_f32_32x32x16_bf16 v[56:71], v[28:31], v[168:171], v[56:71]
    ds_read_b64_tr_b16 v[16:17], v4 offset:2048
    ds_read_b64_tr_b16 v[18:19], v4 offset:3072
    ds_read_b64_tr_b16 v[20:21], v5 offset:2048
    ds_read_b64_tr_b16 v[22:23], v5 offset:3072
    v_mfma_f32_32x32x16_bf16 v[40:55], v[32:35], v[172:175], v[40:55]
    v_lshl_add_u32 v6, s55, 1, v142
    v_lshl_add_u32 v7, s55, 1, v143
    s_cmp_eq_u32 s48, 0
    s_cbranch_scc1 L_pw15
L_pk15:
    s_ff1_i32_b32 s38, s48
    s_bitset0_b32 s48, s38
    s_bitset1_b32 s49, s38
    s_add_u32 s38, s38, s51
    s_and_b32 s38, s38, 15
    s_lshl_b32 s59, s38, 11
    s_add_u32 s39, s20, s59
    v_mfma_f32_32x32x16_bf16 v[56:71], v[36:39], v[172:175], v[56:71]
    buffer_load_dwordx4 v[216:219], v2, s[8:11], s39 offen offset:0 sc1
    buffer_load_dwordx4 v[220:223], v2, s[8:11], s39 offen offset:1024 sc1
    s_waitcnt vmcnt(10) lgkmcnt(0)
    v_mfma_f32_32x32x16_bf16 v[40:55], v[8:11], v[176:179], v[40:55]
    ds_read_b64_tr_b16 v[24:25], v6 offset:0
    ds_read_b64_tr_b16 v[26:27], v6 offset:1024
    ds_read_b64_tr_b16 v[28:29], v7 offset:0
    ds_read_b64_tr_b16 v[30:31], v7 offset:1024
    v_mfma_f32_32x32x16_bf16 v[56:71], v[12:15], v[176:179], v[56:71]
    ds_read_b64_tr_b16 v[32:33], v6 offset:2048
    ds_read_b64_tr_b16 v[34:35], v6 offset:3072
    ds_read_b64_tr_b16 v[36:37], v7 offset:2048
    ds_read_b64_tr_b16 v[38:39], v7 offset:3072
    v_mfma_f32_32x32x16_bf16 v[40:55], v[16:19], v[180:183], v[40:55]
    v_lshl_add_u32 v4, s56, 1, v142
    v_lshl_add_u32 v5, s56, 1, v143
    v_mfma_f32_32x32x16_bf16 v[56:71], v[20:23], v[180:183], v[56:71]
    s_waitcnt vmcnt(8) lgkmcnt(0)
    v_mfma_f32_32x32x16_bf16 v[40:55], v[24:27], v[184:187], v[40:55]
    ds_read_b64_tr_b16 v[8:9], v4 offset:0
    ds_read_b64_tr_b16 v[10:11], v4 offset:1024
    ds_read_b64_tr_b16 v[12:13], v5 offset:0
    ds_read_b64_tr_b16 v[14:15], v5 offset:1024
    v_mfma_f32_32x32x16_bf16 v[56:71], v[28:31], v[184:187], v[56:71]
    ds_read_b64_tr_b16 v[16:17], v4 offset:2048
    ds_read_b64_tr_b16 v[18:19], v4 offset:3072
    ds_read_b64_tr_b16 v[20:21], v5 offset:2048
    ds_read_b64_tr_b16 v[22:23], v5 offset:3072
    v_mfma_f32_32x32x16_bf16 v[40:55], v[32:35], v[188:191], v[40:55]
    v_lshl_add_u32 v6, s57, 1, v142
    v_lshl_add_u32 v7, s57, 1, v143
    v_mfma_f32_32x32x16_bf16 v[56:71], v[36:39], v[188:191], v[56:71]
    s_waitcnt vmcnt(6) lgkmcnt(0)
    v_mfma_f32_32x32x16_bf16 v[40:55], v[8:11], v[192:195], v[40:55]
    ds_read_b64_tr_b16 v[24:25], v6 offset:0
    ds_read_b64_tr_b16 v[26:27], v6 offset:1024
    ds_read_b64_tr_b16 v[28:29], v7 offset:0
    ds_read_b64_tr_b16 v[30:31], v7 offset:1024
    v_mfma_f32_32x32x16_bf16 v[56:71], v[12:15], v[192:195], v[56:71]
    ds_read_b64_tr_b16 v[32:33], v6 offset:2048
    ds_read_b64_tr_b16 v[34:35], v6 offset:3072
    ds_read_b64_tr_b16 v[36:37], v7 offset:2048
    ds_read_b64_tr_b16 v[38:39], v7 offset:3072
    v_mfma_f32_32x32x16_bf16 v[40:55], v[16:19], v[196:199], v[40:55]
    v_lshl_add_u32 v4, s58, 1, v142
    v_lshl_add_u32 v5, s58, 1, v143
    v_mfma_f32_32x32x16_bf16 v[56:71], v[20:23], v[196:199], v[56:71]
    s_lshl_b32 s38, s3, 12
    s_add_u32 s38, s38, 65536
    v_and_b32 v88, 31, v1
    v_lshrrev_b32 v89, 5, v1
    v_and_b32 v90, 7, v1
    v_xor_b32 v89, v89, v90
    v_lshlrev_b32 v89, 4, v89
    v_lshl_add_u32 v88, v88, 7, v89
    v_add_u32 v88, s38, v88
    v_xor_b32 v89, 32, v88
    v_xor_b32 v91, 96, v88
    v_lshrrev_b32 v93, 3, v1
    v_xor_b32 v92, v93, v90
    v_lshlrev_b32 v92, 4, v92
    v_lshl_add_u32 v92, v93, 7, v92
    v_add_u32 v92, s38, v92
    v_lshlrev_b32 v93, 11, v93
    v_lshl_add_u32 v93, v90, 4, v93
    v_xor_b32 v90, 64, v88
    s_waitcnt vmcnt(4) lgkmcnt(0)
    v_mfma_f32_32x32x16_bf16 v[40:55], v[24:27], v[200:203], v[40:55]
    ds_read_b64_tr_b16 v[8:9], v4 offset:0
    ds_read_b64_tr_b16 v[10:11], v4 offset:1024
    ds_read_b64_tr_b16 v[12:13], v5 offset:0
    ds_read_b64_tr_b16 v[14:15], v5 offset:1024
    v_mfma_f32_32x32x16_bf16 v[56:71], v[28:31], v[200:203], v[56:71]
    ds_read_b64_tr_b16 v[16:17], v4 offset:2048
    ds_read_b64_tr_b16 v[18:19], v4 offset:3072
    ds_read_b64_tr_b16 v[20:21], v5 offset:2048
    ds_read_b64_tr_b16 v[22:23], v5 offset:3072
    v_mfma_f32_32x32x16_bf16 v[40:55], v[32:35], v[204:207], v[40:55]
    v_lshl_add_u32 v6, s59, 1, v142
    v_lshl_add_u32 v7, s59, 1, v143
    v_mfma_f32_32x32x16_bf16 v[56:71], v[36:39], v[204:207], v[56:71]
    s_waitcnt vmcnt(2) lgkmcnt(0)
    v_mfma_f32_32x32x16_bf16 v[40:55], v[8:11], v[208:211], v[40:55]
    ds_read_b64_tr_b16 v[24:25], v6 offset:0
    ds_read_b64_tr_b16 v[26:27], v6 offset:1024
    ds_read_b64_tr_b16 v[28:29], v7 offset:0
    ds_read_b64_tr_b16 v[30:31], v7 offset:1024
    v_mfma_f32_32x32x16_bf16 v[56:71], v[12:15], v[208:211], v[56:71]
    ds_read_b64_tr_b16 v[32:33], v6 offset:2048
    ds_read_b64_tr_b16 v[34:35], v6 offset:3072
    ds_read_b64_tr_b16 v[36:37], v7 offset:2048
    ds_read_b64_tr_b16 v[38:39], v7 offset:3072
    v_mfma_f32_32x32x16_bf16 v[40:55], v[16:19], v[212:215], v[40:55]
    v_mfma_f32_32x32x16_bf16 v[56:71], v[20:23], v[212:215], v[56:71]
    s_waitcnt vmcnt(0) lgkmcnt(0)
    v_mfma_f32_32x32x16_bf16 v[40:55], v[24:27], v[216:219], v[40:55]
    v_mfma_f32_32x32x16_bf16 v[56:71], v[28:31], v[216:219], v[56:71]
    v_mfma_f32_32x32x16_bf16 v[40:55], v[32:35], v[220:223], v[40:55]
    v_mfma_f32_32x32x16_bf16 v[56:71], v[36:39], v[220:223], v[56:71]
    s_nop 10
    v_cvt_pk_bf16_f32 v72, v40, v41
    v_cvt_pk_bf16_f32 v73, v42, v43
    v_cvt_pk_bf16_f32 v74, v44, v45
    v_cvt_pk_bf16_f32 v75, v46, v47
    v_cvt_pk_bf16_f32 v76, v48, v49
    v_cvt_pk_bf16_f32 v77, v50, v51
    v_cvt_pk_bf16_f32 v78, v52, v53
    v_cvt_pk_bf16_f32 v79, v54, v55
    s_nop 1
    v_permlane32_swap_b32 v72, v74
    v_permlane32_swap_b32 v73, v75
    v_permlane32_swap_b32 v76, v78
    v_permlane32_swap_b32 v77, v79
    ds_write_b128 v88, v[72:75]
    ds_write_b128 v89, v[76:79]
    v_cvt_pk_bf16_f32 v80, v56, v57
    v_cvt_pk_bf16_f32 v81, v58, v59
    v_cvt_pk_bf16_f32 v82, v60, v61
    v_cvt_pk_bf16_f32 v83, v62, v63
    v_cvt_pk_bf16_f32 v84, v64, v65
    v_cvt_pk_bf16_f32 v85, v66, v67
    v_cvt_pk_bf16_f32 v86, v68, v69
    v_cvt_pk_bf16_f32 v87, v70, v71
    s_nop 1
    v_permlane32_swap_b32 v80, v82
    v_permlane32_swap_b32 v81, v83
    v_permlane32_swap_b32 v84, v86
    v_permlane32_swap_b32 v85, v87
    ds_write_b128 v90, v[80:83]
    ds_write_b128 v91, v[84:87]
    s_waitcnt lgkmcnt(0)
    ds_read_b128 v[96:99], v92 offset:0
    ds_read_b128 v[100:103], v92 offset:1024
    ds_read_b128 v[104:107], v92 offset:2048
    ds_read_b128 v[108:111], v92 offset:3072
    s_waitcnt lgkmcnt(3)
    buffer_store_dwordx4 v[96:99], v93, s[12:15], s21 offen sc1
    s_add_u32 s21, s21, 16384
    s_waitcnt lgkmcnt(2)
    buffer_store_dwordx4 v[100:103], v93, s[12:15], s21 offen sc1
    s_add_u32 s21, s21, 16384
    s_waitcnt lgkmcnt(1)
    buffer_store_dwordx4 v[104:107], v93, s[12:15], s21 offen sc1
    s_add_u32 s21, s21, 16384
    s_waitcnt lgkmcnt(0)
    buffer_store_dwordx4 v[108:111], v93, s[12:15], s21 offen sc1
L_stamps:
L_end:
    s_endpgm
L_far:
    s_mov_b32 s38, 0x40000
L_farp:
    buffer_load_dword v136, v149, s[8:11], s58 offen sc1
    s_waitcnt vmcnt(0)
    v_cmp_ne_u32 vcc, s7, v136
    s_sub_u32 s38, s38, 1
    s_cbranch_scc1 L_farp_x
    s_cbranch_vccz L_farp_x
    s_sleep 2
    s_branch L_farp
L_farp_x:
    s_branch L_far_ok
L_pw0:
    ds_read_b32 v3, v140
    s_waitcnt lgkmcnt(0)
    v_readfirstlane_b32 s48, v3
    s_sub_u32 s50, s50, 1
    s_cselect_b32 s48, 0xffff, s48
    s_mul_i32 s48, s48, 0x10001
    s_lshr_b32 s48, s48, s51
    s_and_b32 s48, s48, 0xffff
    s_andn2_b32 s48, s48, s49
    s_cbranch_scc1 L_pk0
    s_sleep 1
    s_branch L_pw0
L_pw1:
    ds_read_b32 v3, v140
    s_waitcnt lgkmcnt(0)
    v_readfirstlane_b32 s48, v3
    s_sub_u32 s50, s50, 1
    s_cselect_b32 s48, 0xffff, s48
    s_mul_i32 s48, s48, 0x10001
    s_lshr_b32 s48, s48, s51
    s_and_b32 s48, s48, 0xffff
    s_andn2_b32 s48, s48, s49
    s_cbranch_scc1 L_pk1
    s_sleep 1
    s_branch L_pw1
L_pw2:
    ds_read_b32 v3, v140
    s_waitcnt lgkmcnt(0)
    v_readfirstlane_b32 s48, v3
    s_sub_u32 s50, s50, 1
    s_cselect_b32 s48, 0xffff, s48
    s_mul_i32 s48, s48, 0x10001
    s_lshr_b32 s48, s48, s51
    s_and_b32 s48, s48, 0xffff
    s_andn2_b32 s48, s48, s49
    s_cbranch_scc1 L_pk2
    s_sleep 1
    s_branch L_pw2
L_pw3:
    ds_read_b32 v3, v140
    s_waitcnt lgkmcnt(0)
    v_readfirstlane_b32 s48, v3
    s_sub_u32 s50, s50, 1
    s_cselect_b32 s48, 0xffff, s48
    s_mul_i32 s48, s48, 0x10001
    s_lshr_b32 s48, s48, s51
    s_and_b32 s48, s48, 0xffff
    s_andn2_b32 s48, s48, s49
    s_cbranch_scc1 L_pk3
    s_sleep 1
    s_branch L_pw3
L_pw4:
    ds_read_b32 v3, v140
    s_waitcnt lgkmcnt(0)
    v_readfirstlane_b32 s48, v3
    s_sub_u32 s50, s50, 1
    s_cselect_b32 s48, 0xffff, s48
    s_mul_i32 s48, s48, 0x10001
    s_lshr_b32 s48, s48, s51
    s_and_b32 s48, s48, 0xffff
    s_andn2_b32 s48, s48, s49
    s_cbranch_scc1 L_pk4
    s_sleep 1
    s_branch L_pw4
L_pw5:
    ds_read_b32 v3, v140
    s_waitcnt lgkmcnt(0)
    v_readfirstlane_b32 s48, v3
    s_sub_u32 s50, s50, 1
    s_cselect_b32 s48, 0xffff, s48
    s_mul_i32 s48, s48, 0x10001
    s_lshr_b32 s48, s48, s51
    s_and_b32 s48, s48, 0xffff
    s_andn2_b32 s48, s48, s49
    s_cbranch_scc1 L_pk5
    s_sleep 1
    s_branch L_pw5
L_pw6:
    ds_read_b32 v3, v140
    s_waitcnt lgkmcnt(0)
    v_readfirstlane_b32 s48, v3
    s_sub_u32 s50, s50, 1
    s_cselect_b32 s48, 0xffff, s48
    s_mul_i32 s48, s48, 0x10001
    s_lshr_b32 s48, s48, s51
    s_and_b32 s48, s48, 0xffff
    s_andn2_b32 s48, s48, s49
    s_cbranch_scc1 L_pk6
    s_sleep 1
    s_branch L_pw6
L_pw7:
    ds_read_b32 v3, v140
    s_waitcnt lgkmcnt(0)
    v_readfirstlane_b32 s48, v3
    s_sub_u32 s50, s50, 1
    s_cselect_b32 s48, 0xffff, s48
    s_mul_i32 s48, s48, 0x10001
    s_lshr_b32 s48, s48, s51
    s_and_b32 s48, s48, 0xffff
    s_andn2_b32 s48, s48, s49
    s_cbranch_scc1 L_pk7
    s_sleep 1
    s_branch L_pw7
L_pw8:
    ds_read_b32 v3, v140
    s_waitcnt lgkmcnt(0)
    v_readfirstlane_b32 s48, v3
    s_sub_u32 s50, s50, 1
    s_cselect_b32 s48, 0xffff, s48
    s_mul_i32 s48, s48, 0x10001
    s_lshr_b32 s48, s48, s51
    s_and_b32 s48, s48, 0xffff
    s_andn2_b32 s48, s48, s49
    s_cbranch_scc1 L_pk8
    s_sleep 1
    s_branch L_pw8
L_pw9:
    ds_read_b32 v3, v140
    s_waitcnt lgkmcnt(0)
    v_readfirstlane_b32 s48, v3
    s_sub_u32 s50, s50, 1
    s_cselect_b32 s48, 0xffff, s48
    s_mul_i32 s48, s48, 0x10001
    s_lshr_b32 s48, s48, s51
    s_and_b32 s48, s48, 0xffff
    s_andn2_b32 s48, s48, s49
    s_cbranch_scc1 L_pk9
    s_sleep 1
    s_branch L_pw9
L_pw10:
    ds_read_b32 v3, v140
    s_waitcnt lgkmcnt(0)
    v_readfirstlane_b32 s48, v3
    s_sub_u32 s50, s50, 1
    s_cselect_b32 s48, 0xffff, s48
    s_mul_i32 s48, s48, 0x10001
    s_lshr_b32 s48, s48, s51
    s_and_b32 s48, s48, 0xffff
    s_andn2_b32 s48, s48, s49
    s_cbranch_scc1 L_pk10
    s_sleep 1
    s_branch L_pw10
L_pw11:
    ds_read_b32 v3, v140
    s_waitcnt lgkmcnt(0)
    v_readfirstlane_b32 s48, v3
    s_sub_u32 s50, s50, 1
    s_cselect_b32 s48, 0xffff, s48
    s_mul_i32 s48, s48, 0x10001
    s_lshr_b32 s48, s48, s51
    s_and_b32 s48, s48, 0xffff
    s_andn2_b32 s48, s48, s49
    s_cbranch_scc1 L_pk11
    s_sleep 1
    s_branch L_pw11
L_pw12:
    ds_read_b32 v3, v140
    s_waitcnt lgkmcnt(0)
    v_readfirstlane_b32 s48, v3
    s_sub_u32 s50, s50, 1
    s_cselect_b32 s48, 0xffff, s48
    s_mul_i32 s48, s48, 0x10001
    s_lshr_b32 s48, s48, s51
    s_and_b32 s48, s48, 0xffff
    s_andn2_b32 s48, s48, s49
    s_cbranch_scc1 L_pk12
    s_sleep 1
    s_branch L_pw12
L_pw13:
    ds_read_b32 v3, v140
    s_waitcnt lgkmcnt(0)
    v_readfirstlane_b32 s48, v3
    s_sub_u32 s50, s50, 1
    s_cselect_b32 s48, 0xffff, s48
    s_mul_i32 s48, s48, 0x10001
    s_lshr_b32 s48, s48, s51
    s_and_b32 s48, s48, 0xffff
    s_andn2_b32 s48, s48, s49
    s_cbranch_scc1 L_pk13
    s_sleep 1
    s_branch L_pw13
L_pw14:
    ds_read_b32 v3, v140
    s_waitcnt lgkmcnt(0)
    v_readfirstlane_b32 s48, v3
    s_sub_u32 s50, s50, 1
    s_cselect_b32 s48, 0xffff, s48
    s_mul_i32 s48, s48, 0x10001
    s_lshr_b32 s48, s48, s51
    s_and_b32 s48, s48, 0xffff
    s_andn2_b32 s48, s48, s49
    s_cbranch_scc1 L_pk14
    s_sleep 1
    s_branch L_pw14
L_pw15:
    ds_read_b32 v3, v140
    s_waitcnt lgkmcnt(0)
    v_readfirstlane_b32 s48, v3
    s_sub_u32 s50, s50, 1
    s_cselect_b32 s48, 0xffff, s48
    s_mul_i32 s48, s48, 0x10001
    s_lshr_b32 s48, s48, s51
    s_and_b32 s48, s48, 0xffff
    s_andn2_b32 s48, s48, s49
    s_cbranch_scc1 L_pk15
    s_sleep 1
    s_branch L_pw15
L_slow:
    s_sub_u32 s40, s54, s57
    s_lshr_b32 s38, s3, 2
    s_lshl_b32 s38, s38, 16
    s_add_u32 s40, s40, s38
    s_mov_b32 s41, 0
    v_mov_b32 v136, 0xff800000
    v_mov_b32 v137, 0xff800000
L_slow_max:
    s_add_u32 s38, s40, s41
    buffer_load_dwordx4 v[40:43], v2, s[8:11], s38 offen sc1
    s_waitcnt vmcnt(0)
    v_mfma_f32_32x32x16_bf16 v[72:87], v[40:43], v[64:67], 0
    v_mfma_f32_32x32x16_bf16 v[88:103], v[40:43], v[68:71], 0
    s_nop 12
    v_max3_f32 v136, v72, v73, v136
    v_max3_f32 v136, v74, v75, v136
    v_max3_f32 v136, v76, v77, v136
    v_max3_f32 v136, v78, v79, v136
    v_max3_f32 v136, v80, v81, v136
    v_max3_f32 v136, v82, v83, v136
    v_max3_f32 v136, v84, v85, v136
    v_max3_f32 v136, v86, v87, v136
    v_max3_f32 v137, v88, v89, v137
    v_max3_f32 v137, v90, v91, v137
    v_max3_f32 v137, v92, v93, v137
    v_max3_f32 v137, v94, v95, v137
    v_max3_f32 v137, v96, v97, v137
    v_max3_f32 v137, v98, v99, v137
    v_max3_f32 v137, v100, v101, v137
    v_max3_f32 v137, v102, v103, v137
    s_add_u32 s41, s41, 1024
    s_cmp_lt_u32 s41, 65536
    s_cbranch_scc1 L_slow_max
    v_mov_b32 v7, v136
    s_nop 1
    v_permlane32_swap_b32 v7, v136
    s_nop 1
    v_max_f32 v7, v7, v136
    v_sub_f32 v72, 0, v7
    v_sub_f32 v73, 0, v7
    v_pk_mov_b32 v[74:75], v[72:73], v[72:73]
    v_pk_mov_b32 v[76:77], v[72:73], v[72:73]
    v_pk_mov_b32 v[78:79], v[72:73], v[72:73]
    v_pk_mov_b32 v[80:81], v[72:73], v[72:73]
    v_pk_mov_b32 v[82:83], v[72:73], v[72:73]
    v_pk_mov_b32 v[84:85], v[72:73], v[72:73]
    v_pk_mov_b32 v[86:87], v[72:73], v[72:73]
    v_mov_b32 v7, v137
    s_nop 1
    v_permlane32_swap_b32 v7, v137
    s_nop 1
    v_max_f32 v7, v7, v137
    v_sub_f32 v88, 0, v7
    v_sub_f32 v89, 0, v7
    v_pk_mov_b32 v[90:91], v[88:89], v[88:89]
    v_pk_mov_b32 v[92:93], v[88:89], v[88:89]
    v_pk_mov_b32 v[94:95], v[88:89], v[88:89]
    v_pk_mov_b32 v[96:97], v[88:89], v[88:89]
    v_pk_mov_b32 v[98:99], v[88:89], v[88:89]
    v_pk_mov_b32 v[100:101], v[88:89], v[88:89]
    v_pk_mov_b32 v[102:103], v[88:89], v[88:89]
    v_mov_b32 v104, 0
    v_mov_b32 v105, 0
    v_mov_b32 v106, 0
    v_mov_b32 v107, 0
    v_mov_b32 v108, 0
    v_mov_b32 v109, 0
    v_mov_b32 v110, 0
    v_mov_b32 v111, 0
    v_mov_b32 v112, 0
    v_mov_b32 v113, 0
    v_mov_b32 v114, 0
    v_mov_b32 v115, 0
    v_mov_b32 v116, 0
    v_mov_b32 v117, 0
    v_mov_b32 v118, 0
    v_mov_b32 v119, 0
    v_mov_b32 v120, 0
    v_mov_b32 v121, 0
    v_mov_b32 v122, 0
    v_mov_b32 v123, 0
    v_mov_b32 v124, 0
    v_mov_b32 v125, 0
    v_mov_b32 v126, 0
    v_mov_b32 v127, 0
    v_mov_b32 v128, 0
    v_mov_b32 v129, 0
    v_mov_b32 v130, 0
    v_mov_b32 v131, 0
    v_mov_b32 v132, 0
    v_mov_b32 v133, 0
    v_mov_b32 v134, 0
    v_mov_b32 v135, 0
    v_and_b32 v136, 27, v1
    v_cmp_eq_u32 vcc, 16, v136
    v_mov_b32 v137, 0x3f803f80
    v_and_b32 v138, 15, v1
    v_cndmask_b32 v48, 0, v137, vcc
    v_mov_b32 v49, v48
    v_mov_b32 v50, v48
    v_mov_b32 v51, v48
    v_mov_b32 v52, v48
    v_mov_b32 v53, v48
    v_mov_b32 v54, v48
    v_mov_b32 v55, v48
    v_lshlrev_b32 v138, 4, v138
    v_lshrrev_b32 v137, 5, v1
    v_lshl_add_u32 v138, v137, 8, v138
    s_mov_b32 s41, 0
L_slow_pv:
    s_add_u32 s38, s40, s41
    s_add_u32 s39, s38, 4194304
    buffer_load_dwordx4 v[40:43], v2, s[8:11], s38 offen sc1
    s_mov_b32 exec_lo, 0xffff
    s_mov_b32 exec_hi, 0xffff
    buffer_load_dwordx4 v[48:51], v138, s[8:11], s39 offen sc1
    buffer_load_dwordx4 v[52:55], v138, s[8:11], s39 offen offset:512 sc1
    s_mov_b64 exec, -1
    s_waitcnt vmcnt(0)
    v_mfma_f32_32x32x16_bf16 v[8:23], v[40:43], v[64:67], v[72:87]
    v_mfma_f32_32x32x16_bf16 v[24:39], v[40:43], v[68:71], v[88:103]
    s_nop 12
    v_exp_f32 v8, v8
    v_exp_f32 v9, v9
    v_exp_f32 v10, v10
    v_exp_f32 v11, v11
    v_exp_f32 v12, v12
    v_exp_f32 v13, v13
    v_exp_f32 v14, v14
    v_exp_f32 v15, v15
    v_exp_f32 v16, v16
    v_exp_f32 v17, v17
    v_exp_f32 v18, v18
    v_exp_f32 v19, v19
    v_exp_f32 v20, v20
    v_exp_f32 v21, v21
    v_exp_f32 v22, v22
    v_exp_f32 v23, v23
    v_exp_f32 v24, v24
    v_exp_f32 v25, v25
    v_exp_f32 v26, v26
    v_exp_f32 v27, v27
    v_exp_f32 v28, v28
    v_exp_f32 v29, v29
    v_exp_f32 v30, v30
    v_exp_f32 v31, v31
    v_exp_f32 v32, v32
    v_exp_f32 v33, v33
    v_exp_f32 v34, v34
    v_exp_f32 v35, v35
    v_exp_f32 v36, v36
    v_exp_f32 v37, v37
    v_exp_f32 v38, v38
    v_exp_f32 v39, v39
    s_nop 2
    v_smfmac_f32_32x32x32_bf16 v[104:119], v[48:51], v[8:15], v5
    v_smfmac_f32_32x32x32_bf16 v[104:119], v[52:55], v[16:23], v5
    v_smfmac_f32_32x32x32_bf16 v[120:135], v[48:51], v[24:31], v5
    v_smfmac_f32_32x32x32_bf16 v[120:135], v[52:55], v[32:39], v5
    s_add_u32 s41, s41, 1024
    s_cmp_lt_u32 s41, 65536
    s_cbranch_scc1 L_slow_pv
    s_nop 12
    v_rcp_f32 v114, v112
    v_rcp_f32 v130, v128
    s_nop 0
    s_branch L_attn_store
.section .rodata,"a"
.p2align 6
.amdhsa_kernel concat_heads__mha_block__mha_block__prompt_kernel
  .amdhsa_next_free_vgpr 256
  .amdhsa_next_free_sgpr 64
  .amdhsa_accum_offset 256
  .amdhsa_group_segment_fixed_size 0
  .amdhsa_kernarg_size 72
  .amdhsa_user_sgpr_count 2
  .amdhsa_user_sgpr_kernarg_segment_ptr 1
  .amdhsa_system_sgpr_workgroup_id_x 1
.end_amdhsa_kernel
```
